```python
import torch

def _softmax(x, axis=-1):
    return torch.softmax(x, dim=axis)
def _gelu(x):
    return torch.nn.functional.gelu(x, approximate="tanh")
def _silu(x):
    return torch.nn.functional.silu(x)
def _sigmoid(x):
    return torch.sigmoid(x)
def _layernorm(x, axis=-1, eps=1e-5):
    m = x.mean(dim=axis, keepdim=True)
    v = x.var(dim=axis, keepdim=True, unbiased=False)
    return (x - m) / torch.sqrt(v + eps)
def _scatter_add(tgt, idx, src, axis=0):
    return tgt.clone().index_add_(axis, idx, src)
def _segment_sum(src, seg, n):
    out = torch.zeros((n,) + src.shape[1:], dtype=src.dtype)
    return out.index_add_(0, seg, src)
def _pad(x, pw):
    flat = tuple(v for pair in reversed(pw) for v in pair)
    return torch.nn.functional.pad(x, flat)

kernel_name = 'recurrent_scan__grouped_kv_mqa__geglu_ffn__prompt'

def setup_inputs():

    _w = (lambda a: (lambda t: t.to(torch.bfloat16) if t.is_floating_point() else t)(torch.as_tensor(a)))
    def _A_setup():
        B, S, D, H = 1, 2048, 512, 32
        Dh = D // H
        return {
            "x": _w((lambda *s: torch.randn(*s, dtype=torch.bfloat16) * 0.05)(B, S, D)),
            "wq": _w((lambda *s: torch.randn(*s, dtype=torch.bfloat16) * 0.05)(D, H * Dh)),
            "wk": _w((lambda *s: torch.randn(*s, dtype=torch.bfloat16) * 0.05)(D, Dh)),
            "wv": _w((lambda *s: torch.randn(*s, dtype=torch.bfloat16) * 0.05)(D, Dh)),
            "wo": _w((lambda *s: torch.randn(*s, dtype=torch.bfloat16) * 0.05)(H * Dh, D)),
        }
    _A_in = _A_setup()

    def _B_setup():
        B, S, D, F = 1, 2048, 512, 1792
        return {
            "x": _w((lambda *s: torch.randn(*s, dtype=torch.bfloat16) * 0.05)(B, S, D)),
            "w_gate": _w((lambda *s: torch.randn(*s, dtype=torch.bfloat16) * 0.05)(D, F)),
            "w_up": _w((lambda *s: torch.randn(*s, dtype=torch.bfloat16) * 0.05)(D, F)),
            "w_down": _w((lambda *s: torch.randn(*s, dtype=torch.bfloat16) * 0.05)(F, D)),
        }
    _B_in = _B_setup()

    return {
        "A_x": _A_in["x"],
        "A_wq": _A_in["wq"],
        "A_wk": _A_in["wk"],
        "A_wv": _A_in["wv"],
        "A_wo": _A_in["wo"],
        "B_x": _B_in["x"],
        "B_w_gate": _B_in["w_gate"],
        "B_w_up": _B_in["w_up"],
        "B_w_down": _B_in["w_down"],
    }

def reference(A_x, A_wq, A_wk, A_wv, A_wo, B_x, B_w_gate, B_w_up, B_w_down):
    def _A_ref(x, wq, wk, wv, wo):
        B, S, D = x.shape
        H = 32
        Dh = D // H
        q = (lambda x, *d: x.permute(*d))((x @ wq).reshape(B, S, H, Dh), 0, 2, 1, 3)
        k = x @ wk
        v = x @ wv
        scores = torch.einsum("bhqd,bkd->bhqk", q, k) * (Dh ** -0.5)
        p = _softmax(scores, axis=-1)
        o = torch.einsum("bhqk,bkd->bhqd", p, v)
        return (lambda x, *d: x.permute(*d))(o, 0, 2, 1, 3).reshape(B, S, H * Dh) @ wo

    def _B_ref(x, w_gate, w_up, w_down):
        return (_gelu(x @ w_gate) * (x @ w_up)) @ w_down

    x = A_x
    xn = _layernorm(x, axis=-1)
    s = _A_ref(xn, A_wq, A_wk, A_wv, A_wo)
    g = _silu(_B_ref(xn, B_w_gate, B_w_up, B_w_down))
    return x + s * g
```

```asm
; @launch grid=(256,1,1) block=(768,1,1) lds=163840
.amdgcn_target "amdgcn-amd-amdhsa--gfx950"
.text
.globl recurrent_scan__grouped_kv_mqa__geglu_ffn__prompt_kernel
.p2align 8
.type recurrent_scan__grouped_kv_mqa__geglu_ffn__prompt_kernel,@function
recurrent_scan__grouped_kv_mqa__geglu_ffn__prompt_kernel:
    s_cmp_ge_u32 s2, 256
    s_cbranch_scc1 L_end_1
    s_load_dwordx8 s[12:19], s[0:1], 48
    s_load_dwordx8 s[4:11], s[0:1], 0
    s_load_dwordx2 s[22:23], s[0:1], 88
    s_load_dwordx2 s[20:21], s[0:1], 32
    v_lshrrev_b32 v3, 6, v0
    v_and_b32 v1, 63, v0
    v_readfirstlane_b32 s24, v3
    v_lshlrev_b32 v2, 4, v1
    v_and_b32 v7, 15, v1
    v_lshrrev_b32 v8, 4, v1
    s_and_b32 s32, s2, 3
    s_lshl_b32 s32, s32, 2
    s_bfe_u32 s27, s2, 0x20003
    s_add_u32 s25, s32, s27
    s_bfe_u32 s30, s2, 0x10002
    s_mul_i32 s26, s30, 7
    s_lshr_b32 s31, s2, 5
    s_xor_b32 s31, s31, 7
    s_add_u32 s26, s26, s31
    s_add_u32 s28, s30, 14
    s_cmp_eq_u32 s31, 7
    s_cselect_b32 s26, s28, s26
    s_and_b32 s29, s24, 3
    s_cmp_ge_u32 s24, 8
    s_cbranch_scc1 L_svc_2
    s_lshr_b32 s48, s24, 2
    s_lshl_b32 s49, s26, 8
    s_lshl_b32 s27, s24, 2
    v_add_u32 v3, s27, v8
    v_mul_u32_u24 v9, 3584, v3
    s_and_b32 s27, s24, 2
    s_lshl_b32 s27, s27, 2
    v_lshlrev_b32 v4, 1, v8
    v_add_u32 v4, s27, v4
    v_xor_b32 v4, v4, v7
    v_lshl_add_u32 v9, v4, 4, v9
    s_lshl_b32 s51, s24, 10
    s_add_u32 s51, s51, 49152
    s_lshl_b32 s53, s25, 10
    s_lshl_b32 s27, s48, 9
    s_add_u32 s53, s53, s27
    s_lshl_b32 s27, s26, 5
    s_add_u32 s53, s53, s27
    s_lshl_b32 s27, s29, 3
    s_add_u32 s53, s53, s27
    s_add_u32 s53, s53, 7356416
    s_cmp_ge_u32 s26, 14
    s_waitcnt lgkmcnt(0)
    s_cbranch_scc1 L_light_3
    s_mov_b32 s64, s12
    s_and_b32 s65, s13, 0xffff
    s_mov_b32 s66, 1835008
    s_mov_b32 s67, 0x20000
    s_mov_b32 s68, s14
    s_and_b32 s69, s15, 0xffff
    s_mov_b32 s70, 1835008
    s_mov_b32 s71, 0x20000
    s_mov_b32 s54, s32
    s_mul_i32 s50, s32, 114688
    s_add_u32 m0, s51, 0
    s_add_u32 s50, s50, s49
    buffer_load_dwordx4 v9, s[64:67], s50 offen lds
    s_add_u32 m0, s51, 8192
    s_add_u32 s32, s32, 1
    buffer_load_dwordx4 v9, s[68:71], s50 offen lds
    s_and_b32 s32, s32, 15
    s_mov_b32 s40, s22
    s_and_b32 s41, s23, 0xffff
    s_mov_b32 s42, 33554432
    s_mov_b32 s43, 0x20000
    s_add_u32 s36, s22, 7340032
    s_addc_u32 s37, s23, 0
    s_load_dwordx2 s[34:35], s[36:37], 0
    v_lshrrev_b32 v3, 1, v7
    v_xor_b32 v3, v3, v8
    v_lshlrev_b32 v10, 7, v7
    v_lshl_add_u32 v10, v3, 4, v10
    s_lshl_b32 s27, s48, 13
    s_add_u32 s27, s27, 114688
    v_add_u32 v10, s27, v10
    v_xor_b32 v11, 64, v10
    s_lshl_b32 s27, s29, 1
    v_lshrrev_b32 v3, 2, v7
    v_lshl_add_u32 v4, v8, 3, v3
    v_and_b32 v5, 1, v8
    v_lshl_add_u32 v5, v5, 2, v3
    v_xor_b32 v5, s27, v5
    v_lshlrev_b32 v12, 8, v4
    v_lshl_add_u32 v12, v5, 5, v12
    v_and_b32 v5, 3, v1
    v_lshl_add_u32 v12, v5, 3, v12
    v_add_u32 v12, 49152, v12
    v_xor_b32 v13, 32, v12
    s_barrier
    s_mul_i32 s50, s32, 114688
    s_add_u32 m0, s51, 16384
    s_add_u32 s50, s50, s49
    buffer_load_dwordx4 v9, s[64:67], s50 offen lds
    s_add_u32 m0, s51, 24576
    s_add_u32 s32, s32, 1
    buffer_load_dwordx4 v9, s[68:71], s50 offen lds
    s_and_b32 s32, s32, 15
    v_mov_b32 v24, 0
    v_mov_b32 v25, 0
    v_mov_b32 v26, 0
    v_mov_b32 v27, 0
    v_mov_b32 v28, 0
    v_mov_b32 v29, 0
    v_mov_b32 v30, 0
    v_mov_b32 v31, 0
    v_mov_b32 v32, 0
    v_mov_b32 v33, 0
    v_mov_b32 v34, 0
    v_mov_b32 v35, 0
    v_mov_b32 v36, 0
    v_mov_b32 v37, 0
    v_mov_b32 v38, 0
    v_mov_b32 v39, 0
    v_mov_b32 v40, 0
    v_mov_b32 v41, 0
    v_mov_b32 v42, 0
    v_mov_b32 v43, 0
    v_mov_b32 v44, 0
    v_mov_b32 v45, 0
    v_mov_b32 v46, 0
    v_mov_b32 v47, 0
    v_mov_b32 v48, 0
    v_mov_b32 v49, 0
    v_mov_b32 v50, 0
    v_mov_b32 v51, 0
    v_mov_b32 v52, 0
    v_mov_b32 v53, 0
    v_mov_b32 v54, 0
    v_mov_b32 v55, 0
    v_mov_b32 v56, 0
    v_mov_b32 v57, 0
    v_mov_b32 v58, 0
    v_mov_b32 v59, 0
    v_mov_b32 v60, 0
    v_mov_b32 v61, 0
    v_mov_b32 v62, 0
    v_mov_b32 v63, 0
    v_mov_b32 v64, 0
    v_mov_b32 v65, 0
    v_mov_b32 v66, 0
    v_mov_b32 v67, 0
    v_mov_b32 v68, 0
    v_mov_b32 v69, 0
    v_mov_b32 v70, 0
    v_mov_b32 v71, 0
    v_mov_b32 v72, 0
    v_mov_b32 v73, 0
    v_mov_b32 v74, 0
    v_mov_b32 v75, 0
    v_mov_b32 v76, 0
    v_mov_b32 v77, 0
    v_mov_b32 v78, 0
    v_mov_b32 v79, 0
    v_mov_b32 v80, 0
    v_mov_b32 v81, 0
    v_mov_b32 v82, 0
    v_mov_b32 v83, 0
    v_mov_b32 v84, 0
    v_mov_b32 v85, 0
    v_mov_b32 v86, 0
    v_mov_b32 v87, 0
    v_bfe_u32 v3, v1, 2, 2
    v_lshlrev_b32 v16, 7, v3
    v_lshrrev_b32 v4, 5, v1
    v_lshl_add_u32 v16, v4, 9, v16
    v_bfe_u32 v3, v1, 3, 1
    v_lshl_add_u32 v16, v3, 6, v16
    v_bfe_u32 v3, v1, 4, 1
    v_lshl_add_u32 v16, v3, 5, v16
    v_and_b32 v3, 3, v1
    v_lshl_add_u32 v16, v3, 3, v16
    s_lshr_b32 s28, s24, 1
    s_and_b32 s55, s24, 1
    s_lshl_b32 s27, s28, 14
    s_add_u32 s27, s27, 16384
    v_add_u32 v16, s27, v16
    v_xor_b32 v17, 64, v16
    s_lshl_b32 s58, s25, 17
    s_lshl_b32 s27, s30, 16
    s_add_u32 s58, s58, s27
    s_lshl_b32 s27, s55, 15
    s_add_u32 s58, s58, s27
    s_lshl_b32 s27, s28, 13
    s_add_u32 s58, s58, s27
    s_add_u32 s58, s58, 2097152
    s_add_u32 s59, s58, 4096
    s_lshl_b32 s57, s55, 14
    s_lshl_b32 s27, s28, 12
    s_add_u32 s57, s57, s27
    s_add_u32 s57, s57, 114688
    v_add_u32 v18, s57, v2
    s_lshl_b32 s28, s28, 12
    s_add_u32 s57, s28, 147456
    s_cmp_eq_u32 s55, 1
    s_cselect_b32 s57, s28, s57
    v_add_u32 v19, s57, v2
    s_mul_i32 s27, s29, 6144
    s_add_u32 s27, s27, 81920
    v_add_u32 v20, s27, v2
    v_mov_b32 v4, 0x3f803f80
    v_and_b32 v3, 27, v1
    v_cmp_eq_u32 vcc, 16, v3
    s_mov_b32 s60, 0x0000ffff
    s_mov_b32 s61, 0x0000ffff
    v_cndmask_b32 v4, 0, v4, vcc
    v_mov_b32 v152, v4
    v_mov_b32 v153, v4
    v_mov_b32 v154, v4
    v_mov_b32 v155, v4
    v_mov_b32 v156, v4
    v_mov_b32 v157, v4
    v_mov_b32 v158, v4
    v_mov_b32 v159, v4
    v_mov_b32 v160, v4
    v_mov_b32 v161, v4
    v_mov_b32 v162, v4
    v_mov_b32 v163, v4
    v_mov_b32 v164, v4
    v_mov_b32 v165, v4
    v_mov_b32 v166, v4
    v_mov_b32 v167, v4
    s_waitcnt lgkmcnt(0)
    s_mul_i32 s34, s34, 1664525
    s_add_u32 s34, s34, 1013904223
    s_mul_i32 s35, s35, 22695477
    s_add_u32 s35, s35, 1
    s_waitcnt vmcnt(2)
    s_barrier
    ds_read_b128 v[88:91], v10 offset:0
    ds_read_b64_tr_b16 v[120:121], v12 offset:0
    ds_read_b64_tr_b16 v[122:123], v12 offset:1024
    ds_read_b128 v[92:95], v10 offset:2048
    ds_read_b64_tr_b16 v[124:125], v12 offset:8192
    ds_read_b64_tr_b16 v[126:127], v12 offset:9216
    ds_read_b128 v[96:99], v10 offset:4096
    ds_read_b64_tr_b16 v[128:129], v13 offset:0
    ds_read_b64_tr_b16 v[130:131], v13 offset:1024
    ds_read_b128 v[100:103], v10 offset:6144
    ds_read_b64_tr_b16 v[132:133], v13 offset:8192
    ds_read_b64_tr_b16 v[134:135], v13 offset:9216
    s_mul_i32 s50, s32, 114688
    s_add_u32 m0, s51, 32768
    s_add_u32 s50, s50, s49
    buffer_load_dwordx4 v9, s[64:67], s50 offen lds
    s_add_u32 m0, s51, 40960
    s_add_u32 s32, s32, 1
    buffer_load_dwordx4 v9, s[68:71], s50 offen lds
    s_and_b32 s32, s32, 15
    s_waitcnt vmcnt(2) lgkmcnt(0)
    s_barrier
    s_cmp_lg_u32 s48, 1
    s_cbranch_scc1 L_sk_5
    s_mul_i32 s50, s32, 114688
    s_add_u32 m0, s51, 49152
    s_add_u32 s50, s50, s49
    buffer_load_dwordx4 v9, s[64:67], s50 offen lds
    s_add_u32 m0, s51, 57344
    s_add_u32 s32, s32, 1
    buffer_load_dwordx4 v9, s[68:71], s50 offen lds
    s_and_b32 s32, s32, 15
L_sk_5:
    v_mfma_f32_16x16x32_bf16 v[24:27], v[120:123], v[88:91], v[24:27]
    ds_read_b128 v[104:107], v11 offset:0
    v_mfma_f32_16x16x32_bf16 v[28:31], v[124:127], v[88:91], v[28:31]
    ds_read_b64_tr_b16 v[136:137], v12 offset:16384
    v_mfma_f32_16x16x32_bf16 v[32:35], v[128:131], v[88:91], v[32:35]
    ds_read_b64_tr_b16 v[138:139], v12 offset:17408
    v_mfma_f32_16x16x32_bf16 v[36:39], v[132:135], v[88:91], v[36:39]
    ds_read_b128 v[108:111], v11 offset:2048
    v_mfma_f32_16x16x32_bf16 v[40:43], v[120:123], v[92:95], v[40:43]
    ds_read_b64_tr_b16 v[140:141], v12 offset:24576
    v_mfma_f32_16x16x32_bf16 v[44:47], v[124:127], v[92:95], v[44:47]
    ds_read_b64_tr_b16 v[142:143], v12 offset:25600
    v_mfma_f32_16x16x32_bf16 v[48:51], v[128:131], v[92:95], v[48:51]
    ds_read_b128 v[112:115], v11 offset:4096
    v_mfma_f32_16x16x32_bf16 v[52:55], v[132:135], v[92:95], v[52:55]
    ds_read_b64_tr_b16 v[144:145], v13 offset:16384
    v_mfma_f32_16x16x32_bf16 v[56:59], v[120:123], v[96:99], v[56:59]
    ds_read_b64_tr_b16 v[146:147], v13 offset:17408
    s_cmp_lg_u32 s48, 0
    s_cbranch_scc1 L_sk_6
    s_mul_i32 s50, s32, 114688
    s_add_u32 m0, s51, 49152
    s_add_u32 s50, s50, s49
    buffer_load_dwordx4 v9, s[64:67], s50 offen lds
    s_add_u32 m0, s51, 57344
    s_add_u32 s32, s32, 1
    buffer_load_dwordx4 v9, s[68:71], s50 offen lds
    s_and_b32 s32, s32, 15
L_sk_6:
    v_mfma_f32_16x16x32_bf16 v[60:63], v[124:127], v[96:99], v[60:63]
    ds_read_b128 v[116:119], v11 offset:6144
    v_mfma_f32_16x16x32_bf16 v[64:67], v[128:131], v[96:99], v[64:67]
    ds_read_b64_tr_b16 v[148:149], v13 offset:24576
    v_mfma_f32_16x16x32_bf16 v[68:71], v[132:135], v[96:99], v[68:71]
    ds_read_b64_tr_b16 v[150:151], v13 offset:25600
    v_mfma_f32_16x16x32_bf16 v[72:75], v[120:123], v[100:103], v[72:75]
    v_mfma_f32_16x16x32_bf16 v[76:79], v[124:127], v[100:103], v[76:79]
    v_mfma_f32_16x16x32_bf16 v[80:83], v[128:131], v[100:103], v[80:83]
    v_mfma_f32_16x16x32_bf16 v[84:87], v[132:135], v[100:103], v[84:87]
    s_waitcnt vmcnt(2) lgkmcnt(0)
    s_barrier
    s_cmp_lg_u32 s48, 1
    s_cbranch_scc1 L_sk_7
    s_mul_i32 s50, s32, 114688
    s_add_u32 m0, s51, 0
    s_add_u32 s50, s50, s49
    buffer_load_dwordx4 v9, s[64:67], s50 offen lds
    s_add_u32 m0, s51, 8192
    s_add_u32 s32, s32, 1
    buffer_load_dwordx4 v9, s[68:71], s50 offen lds
    s_and_b32 s32, s32, 15
L_sk_7:
    v_mfma_f32_16x16x32_bf16 v[24:27], v[136:139], v[104:107], v[24:27]
    ds_read_b128 v[88:91], v10 offset:16384
    v_mfma_f32_16x16x32_bf16 v[28:31], v[140:143], v[104:107], v[28:31]
    ds_read_b64_tr_b16 v[120:121], v12 offset:32768
    v_mfma_f32_16x16x32_bf16 v[32:35], v[144:147], v[104:107], v[32:35]
    ds_read_b64_tr_b16 v[122:123], v12 offset:33792
    v_mfma_f32_16x16x32_bf16 v[36:39], v[148:151], v[104:107], v[36:39]
    ds_read_b128 v[92:95], v10 offset:18432
    v_mfma_f32_16x16x32_bf16 v[40:43], v[136:139], v[108:111], v[40:43]
    ds_read_b64_tr_b16 v[124:125], v12 offset:40960
    v_mfma_f32_16x16x32_bf16 v[44:47], v[140:143], v[108:111], v[44:47]
    ds_read_b64_tr_b16 v[126:127], v12 offset:41984
    v_mfma_f32_16x16x32_bf16 v[48:51], v[144:147], v[108:111], v[48:51]
    ds_read_b128 v[96:99], v10 offset:20480
    v_mfma_f32_16x16x32_bf16 v[52:55], v[148:151], v[108:111], v[52:55]
    ds_read_b64_tr_b16 v[128:129], v13 offset:32768
    v_mfma_f32_16x16x32_bf16 v[56:59], v[136:139], v[112:115], v[56:59]
    ds_read_b64_tr_b16 v[130:131], v13 offset:33792
    s_cmp_lg_u32 s48, 0
    s_cbranch_scc1 L_sk_8
    s_mul_i32 s50, s32, 114688
    s_add_u32 m0, s51, 0
    s_add_u32 s50, s50, s49
    buffer_load_dwordx4 v9, s[64:67], s50 offen lds
    s_add_u32 m0, s51, 8192
    s_add_u32 s32, s32, 1
    buffer_load_dwordx4 v9, s[68:71], s50 offen lds
    s_and_b32 s32, s32, 15
L_sk_8:
    v_mfma_f32_16x16x32_bf16 v[60:63], v[140:143], v[112:115], v[60:63]
    ds_read_b128 v[100:103], v10 offset:22528
    v_mfma_f32_16x16x32_bf16 v[64:67], v[144:147], v[112:115], v[64:67]
    ds_read_b64_tr_b16 v[132:133], v13 offset:40960
    v_mfma_f32_16x16x32_bf16 v[68:71], v[148:151], v[112:115], v[68:71]
    ds_read_b64_tr_b16 v[134:135], v13 offset:41984
    v_mfma_f32_16x16x32_bf16 v[72:75], v[136:139], v[116:119], v[72:75]
    v_mfma_f32_16x16x32_bf16 v[76:79], v[140:143], v[116:119], v[76:79]
    v_mfma_f32_16x16x32_bf16 v[80:83], v[144:147], v[116:119], v[80:83]
    v_mfma_f32_16x16x32_bf16 v[84:87], v[148:151], v[116:119], v[84:87]
    s_waitcnt vmcnt(2) lgkmcnt(0)
    s_barrier
    s_cmp_lg_u32 s48, 1
    s_cbranch_scc1 L_sk_9
    s_mul_i32 s50, s32, 114688
    s_add_u32 m0, s51, 16384
    s_add_u32 s50, s50, s49
    buffer_load_dwordx4 v9, s[64:67], s50 offen lds
    s_add_u32 m0, s51, 24576
    s_add_u32 s32, s32, 1
    buffer_load_dwordx4 v9, s[68:71], s50 offen lds
    s_and_b32 s32, s32, 15
L_sk_9:
    v_mfma_f32_16x16x32_bf16 v[24:27], v[120:123], v[88:91], v[24:27]
    ds_read_b128 v[104:107], v11 offset:16384
    v_mfma_f32_16x16x32_bf16 v[28:31], v[124:127], v[88:91], v[28:31]
    ds_read_b64_tr_b16 v[136:137], v12 offset:49152
    v_mfma_f32_16x16x32_bf16 v[32:35], v[128:131], v[88:91], v[32:35]
    ds_read_b64_tr_b16 v[138:139], v12 offset:50176
    v_mfma_f32_16x16x32_bf16 v[36:39], v[132:135], v[88:91], v[36:39]
    ds_read_b128 v[108:111], v11 offset:18432
    v_mfma_f32_16x16x32_bf16 v[40:43], v[120:123], v[92:95], v[40:43]
    ds_read_b64_tr_b16 v[140:141], v12 offset:57344
    v_mfma_f32_16x16x32_bf16 v[44:47], v[124:127], v[92:95], v[44:47]
    ds_read_b64_tr_b16 v[142:143], v12 offset:58368
    v_mfma_f32_16x16x32_bf16 v[48:51], v[128:131], v[92:95], v[48:51]
    ds_read_b128 v[112:115], v11 offset:20480
    v_mfma_f32_16x16x32_bf16 v[52:55], v[132:135], v[92:95], v[52:55]
    ds_read_b64_tr_b16 v[144:145], v13 offset:49152
    v_mfma_f32_16x16x32_bf16 v[56:59], v[120:123], v[96:99], v[56:59]
    ds_read_b64_tr_b16 v[146:147], v13 offset:50176
    s_cmp_lg_u32 s48, 0
    s_cbranch_scc1 L_sk_10
    s_mul_i32 s50, s32, 114688
    s_add_u32 m0, s51, 16384
    s_add_u32 s50, s50, s49
    buffer_load_dwordx4 v9, s[64:67], s50 offen lds
    s_add_u32 m0, s51, 24576
    s_add_u32 s32, s32, 1
    buffer_load_dwordx4 v9, s[68:71], s50 offen lds
    s_and_b32 s32, s32, 15
L_sk_10:
    v_mfma_f32_16x16x32_bf16 v[60:63], v[124:127], v[96:99], v[60:63]
    ds_read_b128 v[116:119], v11 offset:22528
    v_mfma_f32_16x16x32_bf16 v[64:67], v[128:131], v[96:99], v[64:67]
    ds_read_b64_tr_b16 v[148:149], v13 offset:57344
    v_mfma_f32_16x16x32_bf16 v[68:71], v[132:135], v[96:99], v[68:71]
    ds_read_b64_tr_b16 v[150:151], v13 offset:58368
    v_mfma_f32_16x16x32_bf16 v[72:75], v[120:123], v[100:103], v[72:75]
    v_mfma_f32_16x16x32_bf16 v[76:79], v[124:127], v[100:103], v[76:79]
    v_mfma_f32_16x16x32_bf16 v[80:83], v[128:131], v[100:103], v[80:83]
    v_mfma_f32_16x16x32_bf16 v[84:87], v[132:135], v[100:103], v[84:87]
    s_waitcnt vmcnt(2) lgkmcnt(0)
    s_barrier
    s_cmp_lg_u32 s48, 1
    s_cbranch_scc1 L_sk_11
    s_mul_i32 s50, s32, 114688
    s_add_u32 m0, s51, 32768
    s_add_u32 s50, s50, s49
    buffer_load_dwordx4 v9, s[64:67], s50 offen lds
    s_add_u32 m0, s51, 40960
    s_add_u32 s32, s32, 1
    buffer_load_dwordx4 v9, s[68:71], s50 offen lds
    s_and_b32 s32, s32, 15
L_sk_11:
    v_mfma_f32_16x16x32_bf16 v[24:27], v[136:139], v[104:107], v[24:27]
    ds_read_b128 v[88:91], v10 offset:32768
    v_mfma_f32_16x16x32_bf16 v[28:31], v[140:143], v[104:107], v[28:31]
    ds_read_b64_tr_b16 v[120:121], v12 offset:0
    v_mfma_f32_16x16x32_bf16 v[32:35], v[144:147], v[104:107], v[32:35]
    ds_read_b64_tr_b16 v[122:123], v12 offset:1024
    v_mfma_f32_16x16x32_bf16 v[36:39], v[148:151], v[104:107], v[36:39]
    ds_read_b128 v[92:95], v10 offset:34816
    v_mfma_f32_16x16x32_bf16 v[40:43], v[136:139], v[108:111], v[40:43]
    ds_read_b64_tr_b16 v[124:125], v12 offset:8192
    v_mfma_f32_16x16x32_bf16 v[44:47], v[140:143], v[108:111], v[44:47]
    ds_read_b64_tr_b16 v[126:127], v12 offset:9216
    v_mfma_f32_16x16x32_bf16 v[48:51], v[144:147], v[108:111], v[48:51]
    ds_read_b128 v[96:99], v10 offset:36864
    v_mfma_f32_16x16x32_bf16 v[52:55], v[148:151], v[108:111], v[52:55]
    ds_read_b64_tr_b16 v[128:129], v13 offset:0
    v_mfma_f32_16x16x32_bf16 v[56:59], v[136:139], v[112:115], v[56:59]
    ds_read_b64_tr_b16 v[130:131], v13 offset:1024
    s_cmp_lg_u32 s48, 0
    s_cbranch_scc1 L_sk_12
    s_mul_i32 s50, s32, 114688
    s_add_u32 m0, s51, 32768
    s_add_u32 s50, s50, s49
    buffer_load_dwordx4 v9, s[64:67], s50 offen lds
    s_add_u32 m0, s51, 40960
    s_add_u32 s32, s32, 1
    buffer_load_dwordx4 v9, s[68:71], s50 offen lds
    s_and_b32 s32, s32, 15
L_sk_12:
    v_mfma_f32_16x16x32_bf16 v[60:63], v[140:143], v[112:115], v[60:63]
    ds_read_b128 v[100:103], v10 offset:38912
    v_mfma_f32_16x16x32_bf16 v[64:67], v[144:147], v[112:115], v[64:67]
    ds_read_b64_tr_b16 v[132:133], v13 offset:8192
    v_mfma_f32_16x16x32_bf16 v[68:71], v[148:151], v[112:115], v[68:71]
    ds_read_b64_tr_b16 v[134:135], v13 offset:9216
    v_mfma_f32_16x16x32_bf16 v[72:75], v[136:139], v[116:119], v[72:75]
    v_mfma_f32_16x16x32_bf16 v[76:79], v[140:143], v[116:119], v[76:79]
    v_mfma_f32_16x16x32_bf16 v[80:83], v[144:147], v[116:119], v[80:83]
    v_mfma_f32_16x16x32_bf16 v[84:87], v[148:151], v[116:119], v[84:87]
    s_waitcnt vmcnt(2) lgkmcnt(0)
    s_barrier
    s_cmp_lg_u32 s48, 1
    s_cbranch_scc1 L_sk_13
    s_mul_i32 s50, s32, 114688
    s_add_u32 m0, s51, 49152
    s_add_u32 s50, s50, s49
    buffer_load_dwordx4 v9, s[64:67], s50 offen lds
    s_add_u32 m0, s51, 57344
    s_add_u32 s32, s32, 1
    buffer_load_dwordx4 v9, s[68:71], s50 offen lds
    s_and_b32 s32, s32, 15
L_sk_13:
    v_mfma_f32_16x16x32_bf16 v[24:27], v[120:123], v[88:91], v[24:27]
    ds_read_b128 v[104:107], v11 offset:32768
    v_mfma_f32_16x16x32_bf16 v[28:31], v[124:127], v[88:91], v[28:31]
    ds_read_b64_tr_b16 v[136:137], v12 offset:16384
    v_mfma_f32_16x16x32_bf16 v[32:35], v[128:131], v[88:91], v[32:35]
    ds_read_b64_tr_b16 v[138:139], v12 offset:17408
    v_mfma_f32_16x16x32_bf16 v[36:39], v[132:135], v[88:91], v[36:39]
    ds_read_b128 v[108:111], v11 offset:34816
    v_mfma_f32_16x16x32_bf16 v[40:43], v[120:123], v[92:95], v[40:43]
    ds_read_b64_tr_b16 v[140:141], v12 offset:24576
    v_mfma_f32_16x16x32_bf16 v[44:47], v[124:127], v[92:95], v[44:47]
    ds_read_b64_tr_b16 v[142:143], v12 offset:25600
    v_mfma_f32_16x16x32_bf16 v[48:51], v[128:131], v[92:95], v[48:51]
    ds_read_b128 v[112:115], v11 offset:36864
    v_mfma_f32_16x16x32_bf16 v[52:55], v[132:135], v[92:95], v[52:55]
    ds_read_b64_tr_b16 v[144:145], v13 offset:16384
    v_mfma_f32_16x16x32_bf16 v[56:59], v[120:123], v[96:99], v[56:59]
    ds_read_b64_tr_b16 v[146:147], v13 offset:17408
    s_cmp_lg_u32 s48, 0
    s_cbranch_scc1 L_sk_14
    s_mul_i32 s50, s32, 114688
    s_add_u32 m0, s51, 49152
    s_add_u32 s50, s50, s49
    buffer_load_dwordx4 v9, s[64:67], s50 offen lds
    s_add_u32 m0, s51, 57344
    s_add_u32 s32, s32, 1
    buffer_load_dwordx4 v9, s[68:71], s50 offen lds
    s_and_b32 s32, s32, 15
L_sk_14:
    v_mfma_f32_16x16x32_bf16 v[60:63], v[124:127], v[96:99], v[60:63]
    ds_read_b128 v[116:119], v11 offset:38912
    v_mfma_f32_16x16x32_bf16 v[64:67], v[128:131], v[96:99], v[64:67]
    ds_read_b64_tr_b16 v[148:149], v13 offset:24576
    v_mfma_f32_16x16x32_bf16 v[68:71], v[132:135], v[96:99], v[68:71]
    ds_read_b64_tr_b16 v[150:151], v13 offset:25600
    v_mfma_f32_16x16x32_bf16 v[72:75], v[120:123], v[100:103], v[72:75]
    v_mfma_f32_16x16x32_bf16 v[76:79], v[124:127], v[100:103], v[76:79]
    v_mfma_f32_16x16x32_bf16 v[80:83], v[128:131], v[100:103], v[80:83]
    v_mfma_f32_16x16x32_bf16 v[84:87], v[132:135], v[100:103], v[84:87]
    s_waitcnt vmcnt(2) lgkmcnt(0)
    s_barrier
    s_cmp_lg_u32 s48, 1
    s_cbranch_scc1 L_sk_15
    s_mul_i32 s50, s32, 114688
    s_add_u32 m0, s51, 0
    s_add_u32 s50, s50, s49
    buffer_load_dwordx4 v9, s[64:67], s50 offen lds
    s_add_u32 m0, s51, 8192
    s_add_u32 s32, s32, 1
    buffer_load_dwordx4 v9, s[68:71], s50 offen lds
    s_and_b32 s32, s32, 15
L_sk_15:
    v_mfma_f32_16x16x32_bf16 v[24:27], v[136:139], v[104:107], v[24:27]
    ds_read_b128 v[88:91], v10 offset:0
    v_mfma_f32_16x16x32_bf16 v[28:31], v[140:143], v[104:107], v[28:31]
    ds_read_b64_tr_b16 v[120:121], v12 offset:32768
    v_mfma_f32_16x16x32_bf16 v[32:35], v[144:147], v[104:107], v[32:35]
    ds_read_b64_tr_b16 v[122:123], v12 offset:33792
    v_mfma_f32_16x16x32_bf16 v[36:39], v[148:151], v[104:107], v[36:39]
    ds_read_b128 v[92:95], v10 offset:2048
    v_mfma_f32_16x16x32_bf16 v[40:43], v[136:139], v[108:111], v[40:43]
    ds_read_b64_tr_b16 v[124:125], v12 offset:40960
    v_mfma_f32_16x16x32_bf16 v[44:47], v[140:143], v[108:111], v[44:47]
    ds_read_b64_tr_b16 v[126:127], v12 offset:41984
    v_mfma_f32_16x16x32_bf16 v[48:51], v[144:147], v[108:111], v[48:51]
    ds_read_b128 v[96:99], v10 offset:4096
    v_mfma_f32_16x16x32_bf16 v[52:55], v[148:151], v[108:111], v[52:55]
    ds_read_b64_tr_b16 v[128:129], v13 offset:32768
    v_mfma_f32_16x16x32_bf16 v[56:59], v[136:139], v[112:115], v[56:59]
    ds_read_b64_tr_b16 v[130:131], v13 offset:33792
    s_cmp_lg_u32 s48, 0
    s_cbranch_scc1 L_sk_16
    s_mul_i32 s50, s32, 114688
    s_add_u32 m0, s51, 0
    s_add_u32 s50, s50, s49
    buffer_load_dwordx4 v9, s[64:67], s50 offen lds
    s_add_u32 m0, s51, 8192
    s_add_u32 s32, s32, 1
    buffer_load_dwordx4 v9, s[68:71], s50 offen lds
    s_and_b32 s32, s32, 15
L_sk_16:
    v_mfma_f32_16x16x32_bf16 v[60:63], v[140:143], v[112:115], v[60:63]
    ds_read_b128 v[100:103], v10 offset:6144
    v_mfma_f32_16x16x32_bf16 v[64:67], v[144:147], v[112:115], v[64:67]
    ds_read_b64_tr_b16 v[132:133], v13 offset:40960
    v_mfma_f32_16x16x32_bf16 v[68:71], v[148:151], v[112:115], v[68:71]
    ds_read_b64_tr_b16 v[134:135], v13 offset:41984
    v_mfma_f32_16x16x32_bf16 v[72:75], v[136:139], v[116:119], v[72:75]
    v_mfma_f32_16x16x32_bf16 v[76:79], v[140:143], v[116:119], v[76:79]
    v_mfma_f32_16x16x32_bf16 v[80:83], v[144:147], v[116:119], v[80:83]
    v_mfma_f32_16x16x32_bf16 v[84:87], v[148:151], v[116:119], v[84:87]
    s_waitcnt vmcnt(2) lgkmcnt(0)
    s_barrier
    s_cmp_lg_u32 s48, 1
    s_cbranch_scc1 L_sk_17
    s_mul_i32 s50, s32, 114688
    s_add_u32 m0, s51, 16384
    s_add_u32 s50, s50, s49
    buffer_load_dwordx4 v9, s[64:67], s50 offen lds
    s_add_u32 m0, s51, 24576
    s_add_u32 s32, s32, 1
    buffer_load_dwordx4 v9, s[68:71], s50 offen lds
    s_and_b32 s32, s32, 15
L_sk_17:
    v_mfma_f32_16x16x32_bf16 v[24:27], v[120:123], v[88:91], v[24:27]
    ds_read_b128 v[104:107], v11 offset:0
    v_mfma_f32_16x16x32_bf16 v[28:31], v[124:127], v[88:91], v[28:31]
    ds_read_b64_tr_b16 v[136:137], v12 offset:49152
    v_mfma_f32_16x16x32_bf16 v[32:35], v[128:131], v[88:91], v[32:35]
    ds_read_b64_tr_b16 v[138:139], v12 offset:50176
    v_mfma_f32_16x16x32_bf16 v[36:39], v[132:135], v[88:91], v[36:39]
    ds_read_b128 v[108:111], v11 offset:2048
    v_mfma_f32_16x16x32_bf16 v[40:43], v[120:123], v[92:95], v[40:43]
    ds_read_b64_tr_b16 v[140:141], v12 offset:57344
    v_mfma_f32_16x16x32_bf16 v[44:47], v[124:127], v[92:95], v[44:47]
    ds_read_b64_tr_b16 v[142:143], v12 offset:58368
    v_mfma_f32_16x16x32_bf16 v[48:51], v[128:131], v[92:95], v[48:51]
    ds_read_b128 v[112:115], v11 offset:4096
    v_mfma_f32_16x16x32_bf16 v[52:55], v[132:135], v[92:95], v[52:55]
    ds_read_b64_tr_b16 v[144:145], v13 offset:49152
    v_mfma_f32_16x16x32_bf16 v[56:59], v[120:123], v[96:99], v[56:59]
    ds_read_b64_tr_b16 v[146:147], v13 offset:50176
    s_cmp_lg_u32 s48, 0
    s_cbranch_scc1 L_sk_18
    s_mul_i32 s50, s32, 114688
    s_add_u32 m0, s51, 16384
    s_add_u32 s50, s50, s49
    buffer_load_dwordx4 v9, s[64:67], s50 offen lds
    s_add_u32 m0, s51, 24576
    s_add_u32 s32, s32, 1
    buffer_load_dwordx4 v9, s[68:71], s50 offen lds
    s_and_b32 s32, s32, 15
L_sk_18:
    v_mfma_f32_16x16x32_bf16 v[60:63], v[124:127], v[96:99], v[60:63]
    ds_read_b128 v[116:119], v11 offset:6144
    v_mfma_f32_16x16x32_bf16 v[64:67], v[128:131], v[96:99], v[64:67]
    ds_read_b64_tr_b16 v[148:149], v13 offset:57344
    v_mfma_f32_16x16x32_bf16 v[68:71], v[132:135], v[96:99], v[68:71]
    ds_read_b64_tr_b16 v[150:151], v13 offset:58368
    v_mfma_f32_16x16x32_bf16 v[72:75], v[120:123], v[100:103], v[72:75]
    v_mfma_f32_16x16x32_bf16 v[76:79], v[124:127], v[100:103], v[76:79]
    v_mfma_f32_16x16x32_bf16 v[80:83], v[128:131], v[100:103], v[80:83]
    v_mfma_f32_16x16x32_bf16 v[84:87], v[132:135], v[100:103], v[84:87]
    s_waitcnt vmcnt(2) lgkmcnt(0)
    s_barrier
    s_cmp_lg_u32 s48, 1
    s_cbranch_scc1 L_sk_19
    s_mul_i32 s50, s32, 114688
    s_add_u32 m0, s51, 32768
    s_add_u32 s50, s50, s49
    buffer_load_dwordx4 v9, s[64:67], s50 offen lds
    s_add_u32 m0, s51, 40960
    s_add_u32 s32, s32, 1
    buffer_load_dwordx4 v9, s[68:71], s50 offen lds
    s_and_b32 s32, s32, 15
L_sk_19:
    v_mfma_f32_16x16x32_bf16 v[24:27], v[136:139], v[104:107], v[24:27]
    ds_read_b128 v[88:91], v10 offset:16384
    v_mfma_f32_16x16x32_bf16 v[28:31], v[140:143], v[104:107], v[28:31]
    ds_read_b64_tr_b16 v[120:121], v12 offset:0
    v_mfma_f32_16x16x32_bf16 v[32:35], v[144:147], v[104:107], v[32:35]
    ds_read_b64_tr_b16 v[122:123], v12 offset:1024
    v_mfma_f32_16x16x32_bf16 v[36:39], v[148:151], v[104:107], v[36:39]
    ds_read_b128 v[92:95], v10 offset:18432
    v_mfma_f32_16x16x32_bf16 v[40:43], v[136:139], v[108:111], v[40:43]
    ds_read_b64_tr_b16 v[124:125], v12 offset:8192
    v_mfma_f32_16x16x32_bf16 v[44:47], v[140:143], v[108:111], v[44:47]
    ds_read_b64_tr_b16 v[126:127], v12 offset:9216
    v_mfma_f32_16x16x32_bf16 v[48:51], v[144:147], v[108:111], v[48:51]
    ds_read_b128 v[96:99], v10 offset:20480
    v_mfma_f32_16x16x32_bf16 v[52:55], v[148:151], v[108:111], v[52:55]
    ds_read_b64_tr_b16 v[128:129], v13 offset:0
    v_mfma_f32_16x16x32_bf16 v[56:59], v[136:139], v[112:115], v[56:59]
    ds_read_b64_tr_b16 v[130:131], v13 offset:1024
    s_cmp_lg_u32 s48, 0
    s_cbranch_scc1 L_sk_20
    s_mul_i32 s50, s32, 114688
    s_add_u32 m0, s51, 32768
    s_add_u32 s50, s50, s49
    buffer_load_dwordx4 v9, s[64:67], s50 offen lds
    s_add_u32 m0, s51, 40960
    s_add_u32 s32, s32, 1
    buffer_load_dwordx4 v9, s[68:71], s50 offen lds
    s_and_b32 s32, s32, 15
L_sk_20:
    v_mfma_f32_16x16x32_bf16 v[60:63], v[140:143], v[112:115], v[60:63]
    ds_read_b128 v[100:103], v10 offset:22528
    v_mfma_f32_16x16x32_bf16 v[64:67], v[144:147], v[112:115], v[64:67]
    ds_read_b64_tr_b16 v[132:133], v13 offset:8192
    v_mfma_f32_16x16x32_bf16 v[68:71], v[148:151], v[112:115], v[68:71]
    ds_read_b64_tr_b16 v[134:135], v13 offset:9216
    v_mfma_f32_16x16x32_bf16 v[72:75], v[136:139], v[116:119], v[72:75]
    v_mfma_f32_16x16x32_bf16 v[76:79], v[140:143], v[116:119], v[76:79]
    v_mfma_f32_16x16x32_bf16 v[80:83], v[144:147], v[116:119], v[80:83]
    v_mfma_f32_16x16x32_bf16 v[84:87], v[148:151], v[116:119], v[84:87]
    s_waitcnt vmcnt(2) lgkmcnt(0)
    s_barrier
    s_cmp_lg_u32 s48, 1
    s_cbranch_scc1 L_sk_21
    s_mul_i32 s50, s32, 114688
    s_add_u32 m0, s51, 49152
    s_add_u32 s50, s50, s49
    buffer_load_dwordx4 v9, s[64:67], s50 offen lds
    s_add_u32 m0, s51, 57344
    s_add_u32 s32, s32, 1
    buffer_load_dwordx4 v9, s[68:71], s50 offen lds
    s_and_b32 s32, s32, 15
L_sk_21:
    v_mfma_f32_16x16x32_bf16 v[24:27], v[120:123], v[88:91], v[24:27]
    ds_read_b128 v[104:107], v11 offset:16384
    v_mfma_f32_16x16x32_bf16 v[28:31], v[124:127], v[88:91], v[28:31]
    ds_read_b64_tr_b16 v[136:137], v12 offset:16384
    v_mfma_f32_16x16x32_bf16 v[32:35], v[128:131], v[88:91], v[32:35]
    ds_read_b64_tr_b16 v[138:139], v12 offset:17408
    v_mfma_f32_16x16x32_bf16 v[36:39], v[132:135], v[88:91], v[36:39]
    ds_read_b128 v[108:111], v11 offset:18432
    v_mfma_f32_16x16x32_bf16 v[40:43], v[120:123], v[92:95], v[40:43]
    ds_read_b64_tr_b16 v[140:141], v12 offset:24576
    v_mfma_f32_16x16x32_bf16 v[44:47], v[124:127], v[92:95], v[44:47]
    ds_read_b64_tr_b16 v[142:143], v12 offset:25600
    v_mfma_f32_16x16x32_bf16 v[48:51], v[128:131], v[92:95], v[48:51]
    ds_read_b128 v[112:115], v11 offset:20480
    v_mfma_f32_16x16x32_bf16 v[52:55], v[132:135], v[92:95], v[52:55]
    ds_read_b64_tr_b16 v[144:145], v13 offset:16384
    v_mfma_f32_16x16x32_bf16 v[56:59], v[120:123], v[96:99], v[56:59]
    ds_read_b64_tr_b16 v[146:147], v13 offset:17408
    s_cmp_lg_u32 s48, 0
    s_cbranch_scc1 L_sk_22
    s_mul_i32 s50, s32, 114688
    s_add_u32 m0, s51, 49152
    s_add_u32 s50, s50, s49
    buffer_load_dwordx4 v9, s[64:67], s50 offen lds
    s_add_u32 m0, s51, 57344
    s_add_u32 s32, s32, 1
    buffer_load_dwordx4 v9, s[68:71], s50 offen lds
    s_and_b32 s32, s32, 15
L_sk_22:
    v_mfma_f32_16x16x32_bf16 v[60:63], v[124:127], v[96:99], v[60:63]
    ds_read_b128 v[116:119], v11 offset:22528
    v_mfma_f32_16x16x32_bf16 v[64:67], v[128:131], v[96:99], v[64:67]
    ds_read_b64_tr_b16 v[148:149], v13 offset:24576
    v_mfma_f32_16x16x32_bf16 v[68:71], v[132:135], v[96:99], v[68:71]
    ds_read_b64_tr_b16 v[150:151], v13 offset:25600
    v_mfma_f32_16x16x32_bf16 v[72:75], v[120:123], v[100:103], v[72:75]
    v_mfma_f32_16x16x32_bf16 v[76:79], v[124:127], v[100:103], v[76:79]
    v_mfma_f32_16x16x32_bf16 v[80:83], v[128:131], v[100:103], v[80:83]
    v_mfma_f32_16x16x32_bf16 v[84:87], v[132:135], v[100:103], v[84:87]
    s_waitcnt vmcnt(2) lgkmcnt(0)
    s_barrier
    s_cmp_lg_u32 s48, 1
    s_cbranch_scc1 L_sk_23
    s_mul_i32 s50, s32, 114688
    s_add_u32 m0, s51, 0
    s_add_u32 s50, s50, s49
    buffer_load_dwordx4 v9, s[64:67], s50 offen lds
    s_add_u32 m0, s51, 8192
    s_add_u32 s32, s32, 1
    buffer_load_dwordx4 v9, s[68:71], s50 offen lds
    s_and_b32 s32, s32, 15
L_sk_23:
    v_mfma_f32_16x16x32_bf16 v[24:27], v[136:139], v[104:107], v[24:27]
    ds_read_b128 v[88:91], v10 offset:32768
    v_mfma_f32_16x16x32_bf16 v[28:31], v[140:143], v[104:107], v[28:31]
    ds_read_b64_tr_b16 v[120:121], v12 offset:32768
    v_mfma_f32_16x16x32_bf16 v[32:35], v[144:147], v[104:107], v[32:35]
    ds_read_b64_tr_b16 v[122:123], v12 offset:33792
    v_mfma_f32_16x16x32_bf16 v[36:39], v[148:151], v[104:107], v[36:39]
    ds_read_b128 v[92:95], v10 offset:34816
    v_mfma_f32_16x16x32_bf16 v[40:43], v[136:139], v[108:111], v[40:43]
    ds_read_b64_tr_b16 v[124:125], v12 offset:40960
    v_mfma_f32_16x16x32_bf16 v[44:47], v[140:143], v[108:111], v[44:47]
    ds_read_b64_tr_b16 v[126:127], v12 offset:41984
    v_mfma_f32_16x16x32_bf16 v[48:51], v[144:147], v[108:111], v[48:51]
    ds_read_b128 v[96:99], v10 offset:36864
    v_mfma_f32_16x16x32_bf16 v[52:55], v[148:151], v[108:111], v[52:55]
    ds_read_b64_tr_b16 v[128:129], v13 offset:32768
    v_mfma_f32_16x16x32_bf16 v[56:59], v[136:139], v[112:115], v[56:59]
    ds_read_b64_tr_b16 v[130:131], v13 offset:33792
    s_cmp_lg_u32 s48, 0
    s_cbranch_scc1 L_sk_24
    s_mul_i32 s50, s32, 114688
    s_add_u32 m0, s51, 0
    s_add_u32 s50, s50, s49
    buffer_load_dwordx4 v9, s[64:67], s50 offen lds
    s_add_u32 m0, s51, 8192
    s_add_u32 s32, s32, 1
    buffer_load_dwordx4 v9, s[68:71], s50 offen lds
    s_and_b32 s32, s32, 15
L_sk_24:
    v_mfma_f32_16x16x32_bf16 v[60:63], v[140:143], v[112:115], v[60:63]
    ds_read_b128 v[100:103], v10 offset:38912
    v_mfma_f32_16x16x32_bf16 v[64:67], v[144:147], v[112:115], v[64:67]
    ds_read_b64_tr_b16 v[132:133], v13 offset:40960
    v_mfma_f32_16x16x32_bf16 v[68:71], v[148:151], v[112:115], v[68:71]
    ds_read_b64_tr_b16 v[134:135], v13 offset:41984
    v_mfma_f32_16x16x32_bf16 v[72:75], v[136:139], v[116:119], v[72:75]
    v_mfma_f32_16x16x32_bf16 v[76:79], v[140:143], v[116:119], v[76:79]
    v_mfma_f32_16x16x32_bf16 v[80:83], v[144:147], v[116:119], v[80:83]
    v_mfma_f32_16x16x32_bf16 v[84:87], v[148:151], v[116:119], v[84:87]
    s_waitcnt vmcnt(2) lgkmcnt(0)
    s_barrier
    s_cmp_lg_u32 s48, 1
    s_cbranch_scc1 L_sk_25
    s_mul_i32 s50, s32, 114688
    s_add_u32 m0, s51, 16384
    s_add_u32 s50, s50, s49
    buffer_load_dwordx4 v9, s[64:67], s50 offen lds
    s_add_u32 m0, s51, 24576
    s_add_u32 s32, s32, 1
    buffer_load_dwordx4 v9, s[68:71], s50 offen lds
    s_and_b32 s32, s32, 15
L_sk_25:
    v_mfma_f32_16x16x32_bf16 v[24:27], v[120:123], v[88:91], v[24:27]
    ds_read_b128 v[104:107], v11 offset:32768
    v_mfma_f32_16x16x32_bf16 v[28:31], v[124:127], v[88:91], v[28:31]
    ds_read_b64_tr_b16 v[136:137], v12 offset:49152
    v_mfma_f32_16x16x32_bf16 v[32:35], v[128:131], v[88:91], v[32:35]
    ds_read_b64_tr_b16 v[138:139], v12 offset:50176
    v_mfma_f32_16x16x32_bf16 v[36:39], v[132:135], v[88:91], v[36:39]
    ds_read_b128 v[108:111], v11 offset:34816
    v_mfma_f32_16x16x32_bf16 v[40:43], v[120:123], v[92:95], v[40:43]
    ds_read_b64_tr_b16 v[140:141], v12 offset:57344
    v_mfma_f32_16x16x32_bf16 v[44:47], v[124:127], v[92:95], v[44:47]
    ds_read_b64_tr_b16 v[142:143], v12 offset:58368
    v_mfma_f32_16x16x32_bf16 v[48:51], v[128:131], v[92:95], v[48:51]
    ds_read_b128 v[112:115], v11 offset:36864
    v_mfma_f32_16x16x32_bf16 v[52:55], v[132:135], v[92:95], v[52:55]
    ds_read_b64_tr_b16 v[144:145], v13 offset:49152
    v_mfma_f32_16x16x32_bf16 v[56:59], v[120:123], v[96:99], v[56:59]
    ds_read_b64_tr_b16 v[146:147], v13 offset:50176
    s_cmp_lg_u32 s48, 0
    s_cbranch_scc1 L_sk_26
    s_mul_i32 s50, s32, 114688
    s_add_u32 m0, s51, 16384
    s_add_u32 s50, s50, s49
    buffer_load_dwordx4 v9, s[64:67], s50 offen lds
    s_add_u32 m0, s51, 24576
    s_add_u32 s32, s32, 1
    buffer_load_dwordx4 v9, s[68:71], s50 offen lds
    s_and_b32 s32, s32, 15
L_sk_26:
    v_mfma_f32_16x16x32_bf16 v[60:63], v[124:127], v[96:99], v[60:63]
    ds_read_b128 v[116:119], v11 offset:38912
    v_mfma_f32_16x16x32_bf16 v[64:67], v[128:131], v[96:99], v[64:67]
    ds_read_b64_tr_b16 v[148:149], v13 offset:57344
    v_mfma_f32_16x16x32_bf16 v[68:71], v[132:135], v[96:99], v[68:71]
    ds_read_b64_tr_b16 v[150:151], v13 offset:58368
    v_mfma_f32_16x16x32_bf16 v[72:75], v[120:123], v[100:103], v[72:75]
    v_mfma_f32_16x16x32_bf16 v[76:79], v[124:127], v[100:103], v[76:79]
    v_mfma_f32_16x16x32_bf16 v[80:83], v[128:131], v[100:103], v[80:83]
    v_mfma_f32_16x16x32_bf16 v[84:87], v[132:135], v[100:103], v[84:87]
    s_waitcnt vmcnt(2) lgkmcnt(0)
    s_barrier
    s_cmp_lg_u32 s48, 1
    s_cbranch_scc1 L_sk_27
    s_mul_i32 s50, s32, 114688
    s_add_u32 m0, s51, 32768
    s_add_u32 s50, s50, s49
    buffer_load_dwordx4 v9, s[64:67], s50 offen lds
    s_add_u32 m0, s51, 40960
    s_add_u32 s32, s32, 1
    buffer_load_dwordx4 v9, s[68:71], s50 offen lds
    s_and_b32 s32, s32, 15
L_sk_27:
    v_mfma_f32_16x16x32_bf16 v[24:27], v[136:139], v[104:107], v[24:27]
    ds_read_b128 v[88:91], v10 offset:0
    v_mfma_f32_16x16x32_bf16 v[28:31], v[140:143], v[104:107], v[28:31]
    ds_read_b64_tr_b16 v[120:121], v12 offset:0
    v_mfma_f32_16x16x32_bf16 v[32:35], v[144:147], v[104:107], v[32:35]
    ds_read_b64_tr_b16 v[122:123], v12 offset:1024
    v_mfma_f32_16x16x32_bf16 v[36:39], v[148:151], v[104:107], v[36:39]
    ds_read_b128 v[92:95], v10 offset:2048
    v_mfma_f32_16x16x32_bf16 v[40:43], v[136:139], v[108:111], v[40:43]
    ds_read_b64_tr_b16 v[124:125], v12 offset:8192
    v_mfma_f32_16x16x32_bf16 v[44:47], v[140:143], v[108:111], v[44:47]
    ds_read_b64_tr_b16 v[126:127], v12 offset:9216
    v_mfma_f32_16x16x32_bf16 v[48:51], v[144:147], v[108:111], v[48:51]
    ds_read_b128 v[96:99], v10 offset:4096
    v_mfma_f32_16x16x32_bf16 v[52:55], v[148:151], v[108:111], v[52:55]
    ds_read_b64_tr_b16 v[128:129], v13 offset:0
    v_mfma_f32_16x16x32_bf16 v[56:59], v[136:139], v[112:115], v[56:59]
    ds_read_b64_tr_b16 v[130:131], v13 offset:1024
    s_cmp_lg_u32 s48, 0
    s_cbranch_scc1 L_sk_28
    s_mul_i32 s50, s32, 114688
    s_add_u32 m0, s51, 32768
    s_add_u32 s50, s50, s49
    buffer_load_dwordx4 v9, s[64:67], s50 offen lds
    s_add_u32 m0, s51, 40960
    s_add_u32 s32, s32, 1
    buffer_load_dwordx4 v9, s[68:71], s50 offen lds
    s_and_b32 s32, s32, 15
L_sk_28:
    v_mfma_f32_16x16x32_bf16 v[60:63], v[140:143], v[112:115], v[60:63]
    ds_read_b128 v[100:103], v10 offset:6144
    v_mfma_f32_16x16x32_bf16 v[64:67], v[144:147], v[112:115], v[64:67]
    ds_read_b64_tr_b16 v[132:133], v13 offset:8192
    v_mfma_f32_16x16x32_bf16 v[68:71], v[148:151], v[112:115], v[68:71]
    ds_read_b64_tr_b16 v[134:135], v13 offset:9216
    v_mfma_f32_16x16x32_bf16 v[72:75], v[136:139], v[116:119], v[72:75]
    v_mfma_f32_16x16x32_bf16 v[76:79], v[140:143], v[116:119], v[76:79]
    v_mfma_f32_16x16x32_bf16 v[80:83], v[144:147], v[116:119], v[80:83]
    v_mfma_f32_16x16x32_bf16 v[84:87], v[148:151], v[116:119], v[84:87]
    s_waitcnt vmcnt(2) lgkmcnt(0)
    s_barrier
    s_cmp_lg_u32 s48, 1
    s_cbranch_scc1 L_sk_29
    s_mul_i32 s50, s32, 114688
    s_add_u32 m0, s51, 49152
    s_add_u32 s50, s50, s49
    buffer_load_dwordx4 v9, s[64:67], s50 offen lds
    s_add_u32 m0, s51, 57344
    s_add_u32 s32, s32, 1
    buffer_load_dwordx4 v9, s[68:71], s50 offen lds
    s_and_b32 s32, s32, 15
L_sk_29:
    v_mfma_f32_16x16x32_bf16 v[24:27], v[120:123], v[88:91], v[24:27]
    ds_read_b128 v[104:107], v11 offset:0
    v_mfma_f32_16x16x32_bf16 v[28:31], v[124:127], v[88:91], v[28:31]
    ds_read_b64_tr_b16 v[136:137], v12 offset:16384
    v_mfma_f32_16x16x32_bf16 v[32:35], v[128:131], v[88:91], v[32:35]
    ds_read_b64_tr_b16 v[138:139], v12 offset:17408
    v_mfma_f32_16x16x32_bf16 v[36:39], v[132:135], v[88:91], v[36:39]
    ds_read_b128 v[108:111], v11 offset:2048
    v_mfma_f32_16x16x32_bf16 v[40:43], v[120:123], v[92:95], v[40:43]
    ds_read_b64_tr_b16 v[140:141], v12 offset:24576
    v_mfma_f32_16x16x32_bf16 v[44:47], v[124:127], v[92:95], v[44:47]
    ds_read_b64_tr_b16 v[142:143], v12 offset:25600
    v_mfma_f32_16x16x32_bf16 v[48:51], v[128:131], v[92:95], v[48:51]
    ds_read_b128 v[112:115], v11 offset:4096
    v_mfma_f32_16x16x32_bf16 v[52:55], v[132:135], v[92:95], v[52:55]
    ds_read_b64_tr_b16 v[144:145], v13 offset:16384
    v_mfma_f32_16x16x32_bf16 v[56:59], v[120:123], v[96:99], v[56:59]
    ds_read_b64_tr_b16 v[146:147], v13 offset:17408
    s_cmp_lg_u32 s48, 0
    s_cbranch_scc1 L_sk_30
    s_mul_i32 s50, s32, 114688
    s_add_u32 m0, s51, 49152
    s_add_u32 s50, s50, s49
    buffer_load_dwordx4 v9, s[64:67], s50 offen lds
    s_add_u32 m0, s51, 57344
    s_add_u32 s32, s32, 1
    buffer_load_dwordx4 v9, s[68:71], s50 offen lds
    s_and_b32 s32, s32, 15
L_sk_30:
    v_mfma_f32_16x16x32_bf16 v[60:63], v[124:127], v[96:99], v[60:63]
    ds_read_b128 v[116:119], v11 offset:6144
    v_mfma_f32_16x16x32_bf16 v[64:67], v[128:131], v[96:99], v[64:67]
    ds_read_b64_tr_b16 v[148:149], v13 offset:24576
    v_mfma_f32_16x16x32_bf16 v[68:71], v[132:135], v[96:99], v[68:71]
    ds_read_b64_tr_b16 v[150:151], v13 offset:25600
    v_mfma_f32_16x16x32_bf16 v[72:75], v[120:123], v[100:103], v[72:75]
    v_mfma_f32_16x16x32_bf16 v[76:79], v[124:127], v[100:103], v[76:79]
    v_mfma_f32_16x16x32_bf16 v[80:83], v[128:131], v[100:103], v[80:83]
    v_mfma_f32_16x16x32_bf16 v[84:87], v[132:135], v[100:103], v[84:87]
    s_waitcnt vmcnt(2) lgkmcnt(0)
    s_barrier
    v_mfma_f32_16x16x32_bf16 v[24:27], v[136:139], v[104:107], v[24:27]
    ds_read_b128 v[88:91], v10 offset:16384
    v_mfma_f32_16x16x32_bf16 v[28:31], v[140:143], v[104:107], v[28:31]
    ds_read_b64_tr_b16 v[120:121], v12 offset:32768
    v_mfma_f32_16x16x32_bf16 v[32:35], v[144:147], v[104:107], v[32:35]
    ds_read_b64_tr_b16 v[122:123], v12 offset:33792
    v_mfma_f32_16x16x32_bf16 v[36:39], v[148:151], v[104:107], v[36:39]
    ds_read_b128 v[92:95], v10 offset:18432
    v_mfma_f32_16x16x32_bf16 v[40:43], v[136:139], v[108:111], v[40:43]
    ds_read_b64_tr_b16 v[124:125], v12 offset:40960
    v_mfma_f32_16x16x32_bf16 v[44:47], v[140:143], v[108:111], v[44:47]
    ds_read_b64_tr_b16 v[126:127], v12 offset:41984
    v_mfma_f32_16x16x32_bf16 v[48:51], v[144:147], v[108:111], v[48:51]
    ds_read_b128 v[96:99], v10 offset:20480
    v_mfma_f32_16x16x32_bf16 v[52:55], v[148:151], v[108:111], v[52:55]
    ds_read_b64_tr_b16 v[128:129], v13 offset:32768
    v_mfma_f32_16x16x32_bf16 v[56:59], v[136:139], v[112:115], v[56:59]
    ds_read_b64_tr_b16 v[130:131], v13 offset:33792
    v_mfma_f32_16x16x32_bf16 v[60:63], v[140:143], v[112:115], v[60:63]
    ds_read_b128 v[100:103], v10 offset:22528
    v_mfma_f32_16x16x32_bf16 v[64:67], v[144:147], v[112:115], v[64:67]
    ds_read_b64_tr_b16 v[132:133], v13 offset:40960
    v_mfma_f32_16x16x32_bf16 v[68:71], v[148:151], v[112:115], v[68:71]
    ds_read_b64_tr_b16 v[134:135], v13 offset:41984
    v_mfma_f32_16x16x32_bf16 v[72:75], v[136:139], v[116:119], v[72:75]
    v_mfma_f32_16x16x32_bf16 v[76:79], v[140:143], v[116:119], v[76:79]
    v_mfma_f32_16x16x32_bf16 v[80:83], v[144:147], v[116:119], v[80:83]
    v_mfma_f32_16x16x32_bf16 v[84:87], v[148:151], v[116:119], v[84:87]
    s_waitcnt vmcnt(0) lgkmcnt(0)
    s_barrier
    v_mfma_f32_16x16x32_bf16 v[24:27], v[120:123], v[88:91], v[24:27]
    ds_read_b128 v[104:107], v11 offset:16384
    v_mfma_f32_16x16x32_bf16 v[28:31], v[124:127], v[88:91], v[28:31]
    ds_read_b64_tr_b16 v[136:137], v12 offset:49152
    v_mfma_f32_16x16x32_bf16 v[32:35], v[128:131], v[88:91], v[32:35]
    ds_read_b64_tr_b16 v[138:139], v12 offset:50176
    v_mfma_f32_16x16x32_bf16 v[36:39], v[132:135], v[88:91], v[36:39]
    ds_read_b128 v[108:111], v11 offset:18432
    v_mfma_f32_16x16x32_bf16 v[40:43], v[120:123], v[92:95], v[40:43]
    ds_read_b64_tr_b16 v[140:141], v12 offset:57344
    v_mfma_f32_16x16x32_bf16 v[44:47], v[124:127], v[92:95], v[44:47]
    ds_read_b64_tr_b16 v[142:143], v12 offset:58368
    v_mfma_f32_16x16x32_bf16 v[48:51], v[128:131], v[92:95], v[48:51]
    ds_read_b128 v[112:115], v11 offset:20480
    v_mfma_f32_16x16x32_bf16 v[52:55], v[132:135], v[92:95], v[52:55]
    ds_read_b64_tr_b16 v[144:145], v13 offset:49152
    v_mfma_f32_16x16x32_bf16 v[56:59], v[120:123], v[96:99], v[56:59]
    ds_read_b64_tr_b16 v[146:147], v13 offset:50176
    v_mfma_f32_16x16x32_bf16 v[60:63], v[124:127], v[96:99], v[60:63]
    ds_read_b128 v[116:119], v11 offset:22528
    v_mfma_f32_16x16x32_bf16 v[64:67], v[128:131], v[96:99], v[64:67]
    ds_read_b64_tr_b16 v[148:149], v13 offset:57344
    v_mfma_f32_16x16x32_bf16 v[68:71], v[132:135], v[96:99], v[68:71]
    ds_read_b64_tr_b16 v[150:151], v13 offset:58368
    v_mfma_f32_16x16x32_bf16 v[72:75], v[120:123], v[100:103], v[72:75]
    v_mfma_f32_16x16x32_bf16 v[76:79], v[124:127], v[100:103], v[76:79]
    v_mfma_f32_16x16x32_bf16 v[80:83], v[128:131], v[100:103], v[80:83]
    v_mfma_f32_16x16x32_bf16 v[84:87], v[132:135], v[100:103], v[84:87]
    s_waitcnt vmcnt(0) lgkmcnt(0)
    s_barrier
    v_mfma_f32_16x16x32_bf16 v[24:27], v[136:139], v[104:107], v[24:27]
    v_mfma_f32_16x16x32_bf16 v[28:31], v[140:143], v[104:107], v[28:31]
    v_mfma_f32_16x16x32_bf16 v[32:35], v[144:147], v[104:107], v[32:35]
    v_mfma_f32_16x16x32_bf16 v[36:39], v[148:151], v[104:107], v[36:39]
    v_mfma_f32_16x16x32_bf16 v[40:43], v[136:139], v[108:111], v[40:43]
    v_mfma_f32_16x16x32_bf16 v[44:47], v[140:143], v[108:111], v[44:47]
    v_mfma_f32_16x16x32_bf16 v[48:51], v[144:147], v[108:111], v[48:51]
    v_mfma_f32_16x16x32_bf16 v[52:55], v[148:151], v[108:111], v[52:55]
    v_mfma_f32_16x16x32_bf16 v[56:59], v[136:139], v[112:115], v[56:59]
    v_mfma_f32_16x16x32_bf16 v[60:63], v[140:143], v[112:115], v[60:63]
    v_mfma_f32_16x16x32_bf16 v[64:67], v[144:147], v[112:115], v[64:67]
    v_mfma_f32_16x16x32_bf16 v[68:71], v[148:151], v[112:115], v[68:71]
    v_mfma_f32_16x16x32_bf16 v[72:75], v[136:139], v[116:119], v[72:75]
    v_mfma_f32_16x16x32_bf16 v[76:79], v[140:143], v[116:119], v[76:79]
    v_mfma_f32_16x16x32_bf16 v[80:83], v[144:147], v[116:119], v[80:83]
    v_mfma_f32_16x16x32_bf16 v[84:87], v[148:151], v[116:119], v[84:87]
    s_lshl_b32 s27, s48, 10
    s_add_u32 s27, s27, 147456
    v_lshl_add_u32 v3, v7, 4, s27
    ds_read_b128 v[88:91], v3 offset:0
    ds_read_b128 v[92:95], v3 offset:256
    ds_read_b128 v[96:99], v3 offset:512
    ds_read_b128 v[100:103], v3 offset:768
    s_lshl_b32 s27, s29, 7
    s_add_u32 s27, s27, 149504
    v_lshl_add_u32 v4, v8, 4, s27
    ds_read_b128 v[120:123], v4 offset:0
    ds_read_b128 v[124:127], v4 offset:512
    ds_read_b128 v[128:131], v4 offset:64
    ds_read_b128 v[132:135], v4 offset:576
    v_lshlrev_b32 v6, 4, v7
    v_lshl_add_u32 v6, v8, 9, v6
    s_mul_i32 s33, s25, 458752
    s_mul_i32 s27, s48, 229376
    s_add_u32 s33, s33, s27
    s_lshl_b32 s27, s26, 13
    s_add_u32 s33, s33, s27
    s_lshl_b32 s27, s29, 11
    s_add_u32 s33, s33, s27
    s_add_u32 s33, s33, 8388608
    s_waitcnt lgkmcnt(0)
    s_setprio 3
    v_mov_b32 v112, v89
    v_mov_b32 v114, v91
    v_pk_fma_f32 v[24:25], v[120:121], v[88:89], v[24:25] op_sel_hi:[1,0,1]
    v_pk_fma_f32 v[26:27], v[122:123], v[88:89], v[26:27] op_sel_hi:[1,0,1]
    v_pk_fma_f32 v[32:33], v[128:129], v[88:89], v[32:33] op_sel_hi:[1,0,1]
    v_pk_fma_f32 v[34:35], v[130:131], v[88:89], v[34:35] op_sel_hi:[1,0,1]
    v_pk_mul_f32 v[104:105], v[24:25], v[24:25]
    v_pk_mul_f32 v[106:107], v[26:27], v[26:27]
    v_pk_mul_f32 v[108:109], v[32:33], v[32:33]
    v_pk_mul_f32 v[110:111], v[34:35], v[34:35]
    v_pk_fma_f32 v[104:105], v[104:105], v[90:91], v[112:113] op_sel_hi:[1,0,0]
    v_pk_fma_f32 v[106:107], v[106:107], v[90:91], v[112:113] op_sel_hi:[1,0,0]
    v_pk_fma_f32 v[108:109], v[108:109], v[90:91], v[112:113] op_sel_hi:[1,0,0]
    v_pk_fma_f32 v[110:111], v[110:111], v[90:91], v[112:113] op_sel_hi:[1,0,0]
    v_pk_mul_f32 v[104:105], v[104:105], v[24:25]
    v_pk_mul_f32 v[106:107], v[106:107], v[26:27]
    v_pk_mul_f32 v[108:109], v[108:109], v[32:33]
    v_pk_mul_f32 v[110:111], v[110:111], v[34:35]
    v_exp_f32 v104, v104
    v_exp_f32 v105, v105
    v_exp_f32 v106, v106
    v_exp_f32 v107, v107
    v_exp_f32 v108, v108
    v_exp_f32 v109, v109
    v_exp_f32 v110, v110
    v_exp_f32 v111, v111
    v_pk_fma_f32 v[28:29], v[124:125], v[88:89], v[28:29] op_sel_hi:[1,0,1]
    v_pk_fma_f32 v[30:31], v[126:127], v[88:89], v[30:31] op_sel_hi:[1,0,1]
    v_pk_fma_f32 v[36:37], v[132:133], v[88:89], v[36:37] op_sel_hi:[1,0,1]
    v_pk_fma_f32 v[38:39], v[134:135], v[88:89], v[38:39] op_sel_hi:[1,0,1]
    v_pk_fma_f32 v[104:105], v[104:105], v[114:115], v[114:115] op_sel_hi:[1,0,0]
    v_pk_fma_f32 v[106:107], v[106:107], v[114:115], v[114:115] op_sel_hi:[1,0,0]
    v_pk_fma_f32 v[108:109], v[108:109], v[114:115], v[114:115] op_sel_hi:[1,0,0]
    v_pk_fma_f32 v[110:111], v[110:111], v[114:115], v[114:115] op_sel_hi:[1,0,0]
    v_rcp_f32 v104, v104
    v_rcp_f32 v105, v105
    v_rcp_f32 v106, v106
    v_rcp_f32 v107, v107
    v_rcp_f32 v108, v108
    v_rcp_f32 v109, v109
    v_rcp_f32 v110, v110
    v_rcp_f32 v111, v111
    v_pk_mul_f32 v[28:29], v[28:29], v[24:25]
    v_pk_mul_f32 v[30:31], v[30:31], v[26:27]
    v_pk_mul_f32 v[36:37], v[36:37], v[32:33]
    v_pk_mul_f32 v[38:39], v[38:39], v[34:35]
    v_pk_mul_f32 v[28:29], v[28:29], v[104:105]
    v_pk_mul_f32 v[30:31], v[30:31], v[106:107]
    v_pk_mul_f32 v[36:37], v[36:37], v[108:109]
    v_pk_mul_f32 v[38:39], v[38:39], v[110:111]
    v_cvt_pk_bf16_f32 v136, v28, v29
    v_cvt_pk_bf16_f32 v137, v30, v31
    v_cvt_pk_bf16_f32 v138, v36, v37
    v_cvt_pk_bf16_f32 v139, v38, v39
    s_nop 1
    v_permlane32_swap_b32 v136, v138
    v_permlane32_swap_b32 v137, v139
    buffer_store_dwordx4 v[136:139], v6, s[40:43], s33 offen offset:0 sc1
    s_setprio 2
    v_mov_b32 v112, v93
    v_mov_b32 v114, v95
    v_pk_fma_f32 v[40:41], v[120:121], v[92:93], v[40:41] op_sel_hi:[1,0,1]
    v_pk_fma_f32 v[42:43], v[122:123], v[92:93], v[42:43] op_sel_hi:[1,0,1]
    v_pk_fma_f32 v[48:49], v[128:129], v[92:93], v[48:49] op_sel_hi:[1,0,1]
    v_pk_fma_f32 v[50:51], v[130:131], v[92:93], v[50:51] op_sel_hi:[1,0,1]
    v_pk_mul_f32 v[104:105], v[40:41], v[40:41]
    v_pk_mul_f32 v[106:107], v[42:43], v[42:43]
    v_pk_mul_f32 v[108:109], v[48:49], v[48:49]
    v_pk_mul_f32 v[110:111], v[50:51], v[50:51]
    v_pk_fma_f32 v[104:105], v[104:105], v[94:95], v[112:113] op_sel_hi:[1,0,0]
    v_pk_fma_f32 v[106:107], v[106:107], v[94:95], v[112:113] op_sel_hi:[1,0,0]
    v_pk_fma_f32 v[108:109], v[108:109], v[94:95], v[112:113] op_sel_hi:[1,0,0]
    v_pk_fma_f32 v[110:111], v[110:111], v[94:95], v[112:113] op_sel_hi:[1,0,0]
    v_pk_mul_f32 v[104:105], v[104:105], v[40:41]
    v_pk_mul_f32 v[106:107], v[106:107], v[42:43]
    v_pk_mul_f32 v[108:109], v[108:109], v[48:49]
    v_pk_mul_f32 v[110:111], v[110:111], v[50:51]
    v_exp_f32 v104, v104
    v_exp_f32 v105, v105
    v_exp_f32 v106, v106
    v_exp_f32 v107, v107
    v_exp_f32 v108, v108
    v_exp_f32 v109, v109
    v_exp_f32 v110, v110
    v_exp_f32 v111, v111
    v_pk_fma_f32 v[44:45], v[124:125], v[92:93], v[44:45] op_sel_hi:[1,0,1]
    v_pk_fma_f32 v[46:47], v[126:127], v[92:93], v[46:47] op_sel_hi:[1,0,1]
    v_pk_fma_f32 v[52:53], v[132:133], v[92:93], v[52:53] op_sel_hi:[1,0,1]
    v_pk_fma_f32 v[54:55], v[134:135], v[92:93], v[54:55] op_sel_hi:[1,0,1]
    v_pk_fma_f32 v[104:105], v[104:105], v[114:115], v[114:115] op_sel_hi:[1,0,0]
    v_pk_fma_f32 v[106:107], v[106:107], v[114:115], v[114:115] op_sel_hi:[1,0,0]
    v_pk_fma_f32 v[108:109], v[108:109], v[114:115], v[114:115] op_sel_hi:[1,0,0]
    v_pk_fma_f32 v[110:111], v[110:111], v[114:115], v[114:115] op_sel_hi:[1,0,0]
    v_rcp_f32 v104, v104
    v_rcp_f32 v105, v105
    v_rcp_f32 v106, v106
    v_rcp_f32 v107, v107
    v_rcp_f32 v108, v108
    v_rcp_f32 v109, v109
    v_rcp_f32 v110, v110
    v_rcp_f32 v111, v111
    v_pk_mul_f32 v[44:45], v[44:45], v[40:41]
    v_pk_mul_f32 v[46:47], v[46:47], v[42:43]
    v_pk_mul_f32 v[52:53], v[52:53], v[48:49]
    v_pk_mul_f32 v[54:55], v[54:55], v[50:51]
    v_pk_mul_f32 v[44:45], v[44:45], v[104:105]
    v_pk_mul_f32 v[46:47], v[46:47], v[106:107]
    v_pk_mul_f32 v[52:53], v[52:53], v[108:109]
    v_pk_mul_f32 v[54:55], v[54:55], v[110:111]
    v_cvt_pk_bf16_f32 v140, v44, v45
    v_cvt_pk_bf16_f32 v141, v46, v47
    v_cvt_pk_bf16_f32 v142, v52, v53
    v_cvt_pk_bf16_f32 v143, v54, v55
    s_nop 1
    v_permlane32_swap_b32 v140, v142
    v_permlane32_swap_b32 v141, v143
    buffer_store_dwordx4 v[140:143], v6, s[40:43], s33 offen offset:256 sc1
    s_add_u32 s33, s33, 114688
    s_setprio 1
    v_mov_b32 v112, v97
    v_mov_b32 v114, v99
    v_pk_fma_f32 v[56:57], v[120:121], v[96:97], v[56:57] op_sel_hi:[1,0,1]
    v_pk_fma_f32 v[58:59], v[122:123], v[96:97], v[58:59] op_sel_hi:[1,0,1]
    v_pk_fma_f32 v[64:65], v[128:129], v[96:97], v[64:65] op_sel_hi:[1,0,1]
    v_pk_fma_f32 v[66:67], v[130:131], v[96:97], v[66:67] op_sel_hi:[1,0,1]
    v_pk_mul_f32 v[104:105], v[56:57], v[56:57]
    v_pk_mul_f32 v[106:107], v[58:59], v[58:59]
    v_pk_mul_f32 v[108:109], v[64:65], v[64:65]
    v_pk_mul_f32 v[110:111], v[66:67], v[66:67]
    v_pk_fma_f32 v[104:105], v[104:105], v[98:99], v[112:113] op_sel_hi:[1,0,0]
    v_pk_fma_f32 v[106:107], v[106:107], v[98:99], v[112:113] op_sel_hi:[1,0,0]
    v_pk_fma_f32 v[108:109], v[108:109], v[98:99], v[112:113] op_sel_hi:[1,0,0]
    v_pk_fma_f32 v[110:111], v[110:111], v[98:99], v[112:113] op_sel_hi:[1,0,0]
    v_pk_mul_f32 v[104:105], v[104:105], v[56:57]
    v_pk_mul_f32 v[106:107], v[106:107], v[58:59]
    v_pk_mul_f32 v[108:109], v[108:109], v[64:65]
    v_pk_mul_f32 v[110:111], v[110:111], v[66:67]
    v_exp_f32 v104, v104
    v_exp_f32 v105, v105
    v_exp_f32 v106, v106
    v_exp_f32 v107, v107
    v_exp_f32 v108, v108
    v_exp_f32 v109, v109
    v_exp_f32 v110, v110
    v_exp_f32 v111, v111
    v_pk_fma_f32 v[60:61], v[124:125], v[96:97], v[60:61] op_sel_hi:[1,0,1]
    v_pk_fma_f32 v[62:63], v[126:127], v[96:97], v[62:63] op_sel_hi:[1,0,1]
    v_pk_fma_f32 v[68:69], v[132:133], v[96:97], v[68:69] op_sel_hi:[1,0,1]
    v_pk_fma_f32 v[70:71], v[134:135], v[96:97], v[70:71] op_sel_hi:[1,0,1]
    v_pk_fma_f32 v[104:105], v[104:105], v[114:115], v[114:115] op_sel_hi:[1,0,0]
    v_pk_fma_f32 v[106:107], v[106:107], v[114:115], v[114:115] op_sel_hi:[1,0,0]
    v_pk_fma_f32 v[108:109], v[108:109], v[114:115], v[114:115] op_sel_hi:[1,0,0]
    v_pk_fma_f32 v[110:111], v[110:111], v[114:115], v[114:115] op_sel_hi:[1,0,0]
    v_rcp_f32 v104, v104
    v_rcp_f32 v105, v105
    v_rcp_f32 v106, v106
    v_rcp_f32 v107, v107
    v_rcp_f32 v108, v108
    v_rcp_f32 v109, v109
    v_rcp_f32 v110, v110
    v_rcp_f32 v111, v111
    v_pk_mul_f32 v[60:61], v[60:61], v[56:57]
    v_pk_mul_f32 v[62:63], v[62:63], v[58:59]
    v_pk_mul_f32 v[68:69], v[68:69], v[64:65]
    v_pk_mul_f32 v[70:71], v[70:71], v[66:67]
    v_pk_mul_f32 v[60:61], v[60:61], v[104:105]
    v_pk_mul_f32 v[62:63], v[62:63], v[106:107]
    v_pk_mul_f32 v[68:69], v[68:69], v[108:109]
    v_pk_mul_f32 v[70:71], v[70:71], v[110:111]
    v_cvt_pk_bf16_f32 v136, v60, v61
    v_cvt_pk_bf16_f32 v137, v62, v63
    v_cvt_pk_bf16_f32 v138, v68, v69
    v_cvt_pk_bf16_f32 v139, v70, v71
    s_nop 1
    v_permlane32_swap_b32 v136, v138
    v_permlane32_swap_b32 v137, v139
    buffer_store_dwordx4 v[136:139], v6, s[40:43], s33 offen offset:0 sc1
    s_setprio 0
    v_mov_b32 v112, v101
    v_mov_b32 v114, v103
    v_pk_fma_f32 v[72:73], v[120:121], v[100:101], v[72:73] op_sel_hi:[1,0,1]
    v_pk_fma_f32 v[74:75], v[122:123], v[100:101], v[74:75] op_sel_hi:[1,0,1]
    v_pk_fma_f32 v[80:81], v[128:129], v[100:101], v[80:81] op_sel_hi:[1,0,1]
    v_pk_fma_f32 v[82:83], v[130:131], v[100:101], v[82:83] op_sel_hi:[1,0,1]
    v_pk_mul_f32 v[104:105], v[72:73], v[72:73]
    v_pk_mul_f32 v[106:107], v[74:75], v[74:75]
    v_pk_mul_f32 v[108:109], v[80:81], v[80:81]
    v_pk_mul_f32 v[110:111], v[82:83], v[82:83]
    v_pk_fma_f32 v[104:105], v[104:105], v[102:103], v[112:113] op_sel_hi:[1,0,0]
    v_pk_fma_f32 v[106:107], v[106:107], v[102:103], v[112:113] op_sel_hi:[1,0,0]
    v_pk_fma_f32 v[108:109], v[108:109], v[102:103], v[112:113] op_sel_hi:[1,0,0]
    v_pk_fma_f32 v[110:111], v[110:111], v[102:103], v[112:113] op_sel_hi:[1,0,0]
    v_pk_mul_f32 v[104:105], v[104:105], v[72:73]
    v_pk_mul_f32 v[106:107], v[106:107], v[74:75]
    v_pk_mul_f32 v[108:109], v[108:109], v[80:81]
    v_pk_mul_f32 v[110:111], v[110:111], v[82:83]
    v_exp_f32 v104, v104
    v_exp_f32 v105, v105
    v_exp_f32 v106, v106
    v_exp_f32 v107, v107
    v_exp_f32 v108, v108
    v_exp_f32 v109, v109
    v_exp_f32 v110, v110
    v_exp_f32 v111, v111
    v_pk_fma_f32 v[76:77], v[124:125], v[100:101], v[76:77] op_sel_hi:[1,0,1]
    v_pk_fma_f32 v[78:79], v[126:127], v[100:101], v[78:79] op_sel_hi:[1,0,1]
    v_pk_fma_f32 v[84:85], v[132:133], v[100:101], v[84:85] op_sel_hi:[1,0,1]
    v_pk_fma_f32 v[86:87], v[134:135], v[100:101], v[86:87] op_sel_hi:[1,0,1]
    v_pk_fma_f32 v[104:105], v[104:105], v[114:115], v[114:115] op_sel_hi:[1,0,0]
    v_pk_fma_f32 v[106:107], v[106:107], v[114:115], v[114:115] op_sel_hi:[1,0,0]
    v_pk_fma_f32 v[108:109], v[108:109], v[114:115], v[114:115] op_sel_hi:[1,0,0]
    v_pk_fma_f32 v[110:111], v[110:111], v[114:115], v[114:115] op_sel_hi:[1,0,0]
    v_rcp_f32 v104, v104
    v_rcp_f32 v105, v105
    v_rcp_f32 v106, v106
    v_rcp_f32 v107, v107
    v_rcp_f32 v108, v108
    v_rcp_f32 v109, v109
    v_rcp_f32 v110, v110
    v_rcp_f32 v111, v111
    v_pk_mul_f32 v[76:77], v[76:77], v[72:73]
    v_pk_mul_f32 v[78:79], v[78:79], v[74:75]
    v_pk_mul_f32 v[84:85], v[84:85], v[80:81]
    v_pk_mul_f32 v[86:87], v[86:87], v[82:83]
    v_pk_mul_f32 v[76:77], v[76:77], v[104:105]
    v_pk_mul_f32 v[78:79], v[78:79], v[106:107]
    v_pk_mul_f32 v[84:85], v[84:85], v[108:109]
    v_pk_mul_f32 v[86:87], v[86:87], v[110:111]
    v_cvt_pk_bf16_f32 v140, v76, v77
    v_cvt_pk_bf16_f32 v141, v78, v79
    v_cvt_pk_bf16_f32 v142, v84, v85
    v_cvt_pk_bf16_f32 v143, v86, v87
    s_nop 1
    v_permlane32_swap_b32 v140, v142
    v_permlane32_swap_b32 v141, v143
    buffer_store_dwordx4 v[140:143], v6, s[40:43], s33 offen offset:256 sc1
    s_branch L_epdone_4
L_light_3:
    s_mov_b32 s44, s4
    s_and_b32 s45, s5, 0xffff
    s_mov_b32 s46, 2097152
    s_mov_b32 s47, 0x20000
    s_cmp_eq_u32 s48, 1
    s_cselect_b64 s[64:65], s[10:11], s[8:9]
    s_and_b32 s65, s65, 0xffff
    s_mov_b32 s66, 16384
    s_mov_b32 s67, 0x20000
    s_lshl_b32 s50, s30, 2
    s_add_u32 s50, s50, s29
    s_lshl_b32 s33, s25, 17
    s_lshl_b32 s27, s50, 14
    s_add_u32 s33, s33, s27
    s_lshl_b32 s27, s48, 13
    s_add_u32 s33, s33, s27
    s_lshl_b32 s28, s29, 14
    s_lshl_b32 s27, s48, 13
    s_add_u32 s28, s28, s27
    s_add_u32 s28, s28, 49152
    s_lshl_b32 s27, s48, 7
    v_xor_b32 v21, s27, v2
    s_add_u32 m0, s28, 0
    v_xor_b32 v22, 0, v21
    buffer_load_dwordx4 v22, s[44:47], s33 offen lds
    s_add_u32 s33, s33, 1024
    s_add_u32 m0, s28, 1024
    v_xor_b32 v22, 16, v21
    buffer_load_dwordx4 v22, s[44:47], s33 offen lds
    s_add_u32 s33, s33, 1024
    s_add_u32 m0, s28, 2048
    v_xor_b32 v22, 32, v21
    buffer_load_dwordx4 v22, s[44:47], s33 offen lds
    s_add_u32 s33, s33, 1024
    s_add_u32 m0, s28, 3072
    v_xor_b32 v22, 48, v21
    buffer_load_dwordx4 v22, s[44:47], s33 offen lds
    s_add_u32 s33, s33, 1024
    s_add_u32 m0, s28, 4096
    v_xor_b32 v22, 64, v21
    buffer_load_dwordx4 v22, s[44:47], s33 offen lds
    s_add_u32 s33, s33, 1024
    s_add_u32 m0, s28, 5120
    v_xor_b32 v22, 80, v21
    buffer_load_dwordx4 v22, s[44:47], s33 offen lds
    s_add_u32 s33, s33, 1024
    s_add_u32 m0, s28, 6144
    v_xor_b32 v22, 96, v21
    buffer_load_dwordx4 v22, s[44:47], s33 offen lds
    s_add_u32 s33, s33, 1024
    s_add_u32 m0, s28, 7168
    v_xor_b32 v22, 112, v21
    buffer_load_dwordx4 v22, s[44:47], s33 offen lds
    s_add_u32 s33, s33, 1024
    v_lshrrev_b32 v4, 1, v1
    v_and_b32 v5, 0x13, v4
    v_and_b32 v6, 4, v4
    v_lshl_or_b32 v5, v6, 1, v5
    v_and_b32 v6, 8, v4
    v_lshrrev_b32 v6, 1, v6
    v_or_b32 v5, v6, v5
    v_lshlrev_b32 v22, 5, v5
    v_and_b32 v3, 1, v1
    v_lshl_add_u32 v22, v3, 4, v22
    s_lshl_b32 s27, s29, 12
    s_lshl_b32 m0, s24, 12
    s_nop 0
    buffer_load_dwordx4 v22, s[64:67], s27 offen offset:0 lds
    buffer_load_dwordx4 v22, s[64:67], s27 offen offset:1024 lds
    buffer_load_dwordx4 v22, s[64:67], s27 offen offset:2048 lds
    buffer_load_dwordx4 v22, s[64:67], s27 offen offset:3072 lds
    s_barrier
    s_mov_b32 s40, s22
    s_and_b32 s41, s23, 0xffff
    s_mov_b32 s42, 33554432
    s_mov_b32 s43, 0x20000
    s_add_u32 s36, s22, 7340032
    s_addc_u32 s37, s23, 0
    s_load_dwordx2 s[34:35], s[36:37], 0
    v_xor_b32 v3, v7, v8
    v_lshlrev_b32 v23, 10, v7
    v_lshl_add_u32 v23, v3, 4, v23
    s_lshl_b32 s27, s29, 14
    s_add_u32 s27, s27, 49152
    v_add_u32 v23, s27, v23
    v_lshrrev_b32 v3, 1, v8
    v_lshlrev_b32 v4, 4, v3
    v_and_b32 v3, 1, v8
    v_lshl_add_u32 v4, v3, 2, v4
    v_lshrrev_b32 v5, 2, v7
    v_add_u32 v4, v4, v5
    v_and_b32 v6, 3, v1
    v_lshlrev_b32 v6, 3, v6
    v_lshl_add_u32 v24, v4, 5, v6
    s_lshl_b32 s27, s48, 14
    v_add_u32 v24, s27, v24
    v_mov_b32 v28, 0x3f803f80
    v_mov_b32 v29, 0x3f803f80
    v_mov_b32 v30, 0x3f803f80
    v_mov_b32 v31, 0x3f803f80
    v_bfe_u32 v3, v1, 2, 2
    v_lshlrev_b32 v16, 7, v3
    v_lshrrev_b32 v4, 5, v1
    v_lshl_add_u32 v16, v4, 9, v16
    v_bfe_u32 v3, v1, 3, 1
    v_lshl_add_u32 v16, v3, 6, v16
    v_bfe_u32 v3, v1, 4, 1
    v_lshl_add_u32 v16, v3, 5, v16
    v_and_b32 v3, 3, v1
    v_lshl_add_u32 v16, v3, 3, v16
    s_lshr_b32 s28, s24, 1
    s_and_b32 s55, s24, 1
    s_lshl_b32 s27, s28, 14
    s_add_u32 s27, s27, 16384
    v_add_u32 v16, s27, v16
    v_xor_b32 v17, 64, v16
    s_lshl_b32 s58, s25, 17
    s_lshl_b32 s27, s30, 16
    s_add_u32 s58, s58, s27
    s_lshl_b32 s27, s55, 15
    s_add_u32 s58, s58, s27
    s_lshl_b32 s27, s28, 13
    s_add_u32 s58, s58, s27
    s_add_u32 s58, s58, 2097152
    s_add_u32 s59, s58, 4096
    s_lshl_b32 s57, s55, 14
    s_lshl_b32 s27, s28, 12
    s_add_u32 s57, s57, s27
    s_add_u32 s57, s57, 114688
    v_add_u32 v18, s57, v2
    s_lshl_b32 s28, s28, 12
    s_add_u32 s57, s28, 147456
    s_cmp_eq_u32 s55, 1
    s_cselect_b32 s57, s28, s57
    v_add_u32 v19, s57, v2
    s_mul_i32 s27, s29, 6144
    s_add_u32 s27, s27, 81920
    v_add_u32 v20, s27, v2
    v_mov_b32 v4, 0x3f803f80
    v_and_b32 v3, 27, v1
    v_cmp_eq_u32 vcc, 16, v3
    s_mov_b32 s60, 0x0000ffff
    s_mov_b32 s61, 0x0000ffff
    v_cndmask_b32 v4, 0, v4, vcc
    v_mov_b32 v152, v4
    v_mov_b32 v153, v4
    v_mov_b32 v154, v4
    v_mov_b32 v155, v4
    v_mov_b32 v156, v4
    v_mov_b32 v157, v4
    v_mov_b32 v158, v4
    v_mov_b32 v159, v4
    v_mov_b32 v160, v4
    v_mov_b32 v161, v4
    v_mov_b32 v162, v4
    v_mov_b32 v163, v4
    v_mov_b32 v164, v4
    v_mov_b32 v165, v4
    v_mov_b32 v166, v4
    v_mov_b32 v167, v4
    s_waitcnt lgkmcnt(0)
    s_mul_i32 s34, s34, 1664525
    s_add_u32 s34, s34, 1013904223
    s_mul_i32 s35, s35, 22695477
    s_add_u32 s35, s35, 1
    v_mov_b32 v146, s34
    v_mov_b32 v147, s35
    s_waitcnt vmcnt(0)
    s_barrier
    v_xor_b32 v3, 64, v23
    v_xor_b32 v4, 128, v23
    v_xor_b32 v5, 192, v23
    ds_read_b128 v[64:67], v23 offset:0
    ds_read_b128 v[68:71], v3 offset:0
    ds_read_b128 v[72:75], v4 offset:0
    ds_read_b128 v[76:79], v5 offset:0
    ds_read_b128 v[80:83], v23 offset:256
    ds_read_b128 v[84:87], v3 offset:256
    ds_read_b128 v[88:91], v4 offset:256
    ds_read_b128 v[92:95], v5 offset:256
    ds_read_b128 v[96:99], v23 offset:512
    ds_read_b128 v[100:103], v3 offset:512
    ds_read_b128 v[104:107], v4 offset:512
    ds_read_b128 v[108:111], v5 offset:512
    s_waitcnt lgkmcnt(8)
    ds_read_b128 v[112:115], v23 offset:768
    ds_read_b128 v[116:119], v3 offset:768
    ds_read_b128 v[120:123], v4 offset:768
    ds_read_b128 v[124:127], v5 offset:768
    s_cmp_eq_u32 s48, 1
    s_cbranch_scc1 L_tv_31
    s_setprio 3
    s_waitcnt lgkmcnt(8)
    v_mfma_f32_16x16x32_bf16 v[136:139], v[28:31], v[64:67], 0
    v_mfma_f32_16x16x32_bf16 v[140:143], v[64:67], v[64:67], 0
    v_mfma_f32_16x16x32_bf16 v[136:139], v[28:31], v[68:71], v[136:139]
    v_mfma_f32_16x16x32_bf16 v[140:143], v[68:71], v[68:71], v[140:143]
    v_mfma_f32_16x16x32_bf16 v[136:139], v[28:31], v[72:75], v[136:139]
    v_mfma_f32_16x16x32_bf16 v[140:143], v[72:75], v[72:75], v[140:143]
    v_mfma_f32_16x16x32_bf16 v[136:139], v[28:31], v[76:79], v[136:139]
    v_mfma_f32_16x16x32_bf16 v[140:143], v[76:79], v[76:79], v[140:143]
    s_waitcnt lgkmcnt(8)
    v_mfma_f32_16x16x32_bf16 v[136:139], v[28:31], v[80:83], v[136:139]
    v_mfma_f32_16x16x32_bf16 v[140:143], v[80:83], v[80:83], v[140:143]
    v_mfma_f32_16x16x32_bf16 v[136:139], v[28:31], v[84:87], v[136:139]
    v_mfma_f32_16x16x32_bf16 v[140:143], v[84:87], v[84:87], v[140:143]
    v_mfma_f32_16x16x32_bf16 v[136:139], v[28:31], v[88:91], v[136:139]
    v_mfma_f32_16x16x32_bf16 v[140:143], v[88:91], v[88:91], v[140:143]
    v_mfma_f32_16x16x32_bf16 v[136:139], v[28:31], v[92:95], v[136:139]
    v_mfma_f32_16x16x32_bf16 v[140:143], v[92:95], v[92:95], v[140:143]
    s_waitcnt lgkmcnt(4)
    v_mfma_f32_16x16x32_bf16 v[136:139], v[28:31], v[96:99], v[136:139]
    v_mfma_f32_16x16x32_bf16 v[140:143], v[96:99], v[96:99], v[140:143]
    v_mfma_f32_16x16x32_bf16 v[136:139], v[28:31], v[100:103], v[136:139]
    v_mfma_f32_16x16x32_bf16 v[140:143], v[100:103], v[100:103], v[140:143]
    v_mfma_f32_16x16x32_bf16 v[136:139], v[28:31], v[104:107], v[136:139]
    v_mfma_f32_16x16x32_bf16 v[140:143], v[104:107], v[104:107], v[140:143]
    v_mfma_f32_16x16x32_bf16 v[136:139], v[28:31], v[108:111], v[136:139]
    v_mfma_f32_16x16x32_bf16 v[140:143], v[108:111], v[108:111], v[140:143]
    s_waitcnt lgkmcnt(0)
    v_mfma_f32_16x16x32_bf16 v[136:139], v[28:31], v[112:115], v[136:139]
    v_mfma_f32_16x16x32_bf16 v[140:143], v[112:115], v[112:115], v[140:143]
    v_mfma_f32_16x16x32_bf16 v[136:139], v[28:31], v[116:119], v[136:139]
    v_mfma_f32_16x16x32_bf16 v[140:143], v[116:119], v[116:119], v[140:143]
    v_mfma_f32_16x16x32_bf16 v[136:139], v[28:31], v[120:123], v[136:139]
    v_mfma_f32_16x16x32_bf16 v[140:143], v[120:123], v[120:123], v[140:143]
    v_mfma_f32_16x16x32_bf16 v[136:139], v[28:31], v[124:127], v[136:139]
    v_mfma_f32_16x16x32_bf16 v[140:143], v[124:127], v[124:127], v[140:143]
    v_and_b32 v4, 3, v7
    v_lshrrev_b32 v6, 2, v7
    v_lshlrev_b32 v5, 4, v7
    v_cmp_eq_u32 vcc, 1, v4
    s_nop 3
    v_cndmask_b32 v3, v140, v141, vcc
    v_cmp_eq_u32 vcc, 2, v4
    s_nop 1
    v_cndmask_b32 v3, v3, v142, vcc
    v_cmp_eq_u32 vcc, 3, v4
    s_nop 1
    v_cndmask_b32 v3, v3, v143, vcc
    v_mul_f32 v144, 0xbb000000, v136
    v_mul_f32 v3, 0x3b000000, v3
    v_fma_f32 v3, -v144, v144, v3
    v_max_f32 v3, 0, v3
    v_add_f32 v145, 0x3727c5ac, v3
    v_cmp_eq_u32 vcc, v6, v8
    s_lshl_b32 s33, s25, 11
    s_lshl_b32 s27, s50, 8
    s_add_u32 s33, s33, s27
    s_add_u32 s33, s33, 7405568
    s_and_saveexec_b64 s[68:69], vcc
    buffer_store_dwordx4 v[144:147], v5, s[40:43], s33 offen sc1
    s_mov_b64 exec, s[68:69]
    s_setprio 0
    s_barrier
    s_barrier
    s_waitcnt lgkmcnt(0)
    ds_read_b64_tr_b16 v[32:33], v24 offset:0
    ds_read_b64_tr_b16 v[34:35], v24 offset:256
    ds_read_b64_tr_b16 v[36:37], v24 offset:1024
    ds_read_b64_tr_b16 v[38:39], v24 offset:1280
    ds_read_b64_tr_b16 v[40:41], v24 offset:2048
    ds_read_b64_tr_b16 v[42:43], v24 offset:2304
    ds_read_b64_tr_b16 v[44:45], v24 offset:3072
    ds_read_b64_tr_b16 v[46:47], v24 offset:3328
    s_waitcnt lgkmcnt(0)
    ds_read_b64_tr_b16 v[48:49], v24 offset:4096
    ds_read_b64_tr_b16 v[50:51], v24 offset:4352
    ds_read_b64_tr_b16 v[52:53], v24 offset:5120
    ds_read_b64_tr_b16 v[54:55], v24 offset:5376
    ds_read_b64_tr_b16 v[56:57], v24 offset:6144
    ds_read_b64_tr_b16 v[58:59], v24 offset:6400
    ds_read_b64_tr_b16 v[60:61], v24 offset:7168
    ds_read_b64_tr_b16 v[62:63], v24 offset:7424
    v_mfma_f32_16x16x32_bf16 v[128:131], v[32:35], v[64:67], 0
    v_mfma_f32_16x16x32_bf16 v[132:135], v[32:35], v[28:31], 0
    v_mfma_f32_16x16x32_bf16 v[128:131], v[36:39], v[68:71], v[128:131]
    v_mfma_f32_16x16x32_bf16 v[132:135], v[36:39], v[28:31], v[132:135]
    v_mfma_f32_16x16x32_bf16 v[128:131], v[40:43], v[72:75], v[128:131]
    v_mfma_f32_16x16x32_bf16 v[132:135], v[40:43], v[28:31], v[132:135]
    v_mfma_f32_16x16x32_bf16 v[128:131], v[44:47], v[76:79], v[128:131]
    v_mfma_f32_16x16x32_bf16 v[132:135], v[44:47], v[28:31], v[132:135]
    s_waitcnt lgkmcnt(0)
    ds_read_b64_tr_b16 v[32:33], v24 offset:8192
    ds_read_b64_tr_b16 v[34:35], v24 offset:8448
    ds_read_b64_tr_b16 v[36:37], v24 offset:9216
    ds_read_b64_tr_b16 v[38:39], v24 offset:9472
    ds_read_b64_tr_b16 v[40:41], v24 offset:10240
    ds_read_b64_tr_b16 v[42:43], v24 offset:10496
    ds_read_b64_tr_b16 v[44:45], v24 offset:11264
    ds_read_b64_tr_b16 v[46:47], v24 offset:11520
    v_mfma_f32_16x16x32_bf16 v[128:131], v[48:51], v[80:83], v[128:131]
    v_mfma_f32_16x16x32_bf16 v[132:135], v[48:51], v[28:31], v[132:135]
    v_mfma_f32_16x16x32_bf16 v[128:131], v[52:55], v[84:87], v[128:131]
    v_mfma_f32_16x16x32_bf16 v[132:135], v[52:55], v[28:31], v[132:135]
    v_mfma_f32_16x16x32_bf16 v[128:131], v[56:59], v[88:91], v[128:131]
    v_mfma_f32_16x16x32_bf16 v[132:135], v[56:59], v[28:31], v[132:135]
    v_mfma_f32_16x16x32_bf16 v[128:131], v[60:63], v[92:95], v[128:131]
    v_mfma_f32_16x16x32_bf16 v[132:135], v[60:63], v[28:31], v[132:135]
    s_barrier
    s_waitcnt lgkmcnt(0)
    ds_read_b64_tr_b16 v[48:49], v24 offset:12288
    ds_read_b64_tr_b16 v[50:51], v24 offset:12544
    ds_read_b64_tr_b16 v[52:53], v24 offset:13312
    ds_read_b64_tr_b16 v[54:55], v24 offset:13568
    ds_read_b64_tr_b16 v[56:57], v24 offset:14336
    ds_read_b64_tr_b16 v[58:59], v24 offset:14592
    ds_read_b64_tr_b16 v[60:61], v24 offset:15360
    ds_read_b64_tr_b16 v[62:63], v24 offset:15616
    v_mfma_f32_16x16x32_bf16 v[128:131], v[32:35], v[96:99], v[128:131]
    v_mfma_f32_16x16x32_bf16 v[132:135], v[32:35], v[28:31], v[132:135]
    v_mfma_f32_16x16x32_bf16 v[128:131], v[36:39], v[100:103], v[128:131]
    v_mfma_f32_16x16x32_bf16 v[132:135], v[36:39], v[28:31], v[132:135]
    v_mfma_f32_16x16x32_bf16 v[128:131], v[40:43], v[104:107], v[128:131]
    v_mfma_f32_16x16x32_bf16 v[132:135], v[40:43], v[28:31], v[132:135]
    v_mfma_f32_16x16x32_bf16 v[128:131], v[44:47], v[108:111], v[128:131]
    v_mfma_f32_16x16x32_bf16 v[132:135], v[44:47], v[28:31], v[132:135]
    s_waitcnt lgkmcnt(0)
    v_mfma_f32_16x16x32_bf16 v[128:131], v[48:51], v[112:115], v[128:131]
    v_mfma_f32_16x16x32_bf16 v[132:135], v[48:51], v[28:31], v[132:135]
    v_mfma_f32_16x16x32_bf16 v[128:131], v[52:55], v[116:119], v[128:131]
    v_mfma_f32_16x16x32_bf16 v[132:135], v[52:55], v[28:31], v[132:135]
    v_mfma_f32_16x16x32_bf16 v[128:131], v[56:59], v[120:123], v[128:131]
    v_mfma_f32_16x16x32_bf16 v[132:135], v[56:59], v[28:31], v[132:135]
    v_mfma_f32_16x16x32_bf16 v[128:131], v[60:63], v[124:127], v[128:131]
    v_mfma_f32_16x16x32_bf16 v[132:135], v[60:63], v[28:31], v[132:135]
    s_barrier
    s_nop 3
    s_branch L_tj_32
L_tv_31:
    s_waitcnt lgkmcnt(0)
    ds_read_b64_tr_b16 v[32:33], v24 offset:0
    ds_read_b64_tr_b16 v[34:35], v24 offset:256
    ds_read_b64_tr_b16 v[36:37], v24 offset:1024
    ds_read_b64_tr_b16 v[38:39], v24 offset:1280
    ds_read_b64_tr_b16 v[40:41], v24 offset:2048
    ds_read_b64_tr_b16 v[42:43], v24 offset:2304
    ds_read_b64_tr_b16 v[44:45], v24 offset:3072
    ds_read_b64_tr_b16 v[46:47], v24 offset:3328
    s_waitcnt lgkmcnt(0)
    ds_read_b64_tr_b16 v[48:49], v24 offset:4096
    ds_read_b64_tr_b16 v[50:51], v24 offset:4352
    ds_read_b64_tr_b16 v[52:53], v24 offset:5120
    ds_read_b64_tr_b16 v[54:55], v24 offset:5376
    ds_read_b64_tr_b16 v[56:57], v24 offset:6144
    ds_read_b64_tr_b16 v[58:59], v24 offset:6400
    ds_read_b64_tr_b16 v[60:61], v24 offset:7168
    ds_read_b64_tr_b16 v[62:63], v24 offset:7424
    v_mfma_f32_16x16x32_bf16 v[128:131], v[64:67], v[32:35], 0
    v_mfma_f32_16x16x32_bf16 v[132:135], v[28:31], v[32:35], 0
    v_mfma_f32_16x16x32_bf16 v[128:131], v[68:71], v[36:39], v[128:131]
    v_mfma_f32_16x16x32_bf16 v[132:135], v[28:31], v[36:39], v[132:135]
    v_mfma_f32_16x16x32_bf16 v[128:131], v[72:75], v[40:43], v[128:131]
    v_mfma_f32_16x16x32_bf16 v[132:135], v[28:31], v[40:43], v[132:135]
    v_mfma_f32_16x16x32_bf16 v[128:131], v[76:79], v[44:47], v[128:131]
    v_mfma_f32_16x16x32_bf16 v[132:135], v[28:31], v[44:47], v[132:135]
    s_waitcnt lgkmcnt(0)
    ds_read_b64_tr_b16 v[32:33], v24 offset:8192
    ds_read_b64_tr_b16 v[34:35], v24 offset:8448
    ds_read_b64_tr_b16 v[36:37], v24 offset:9216
    ds_read_b64_tr_b16 v[38:39], v24 offset:9472
    ds_read_b64_tr_b16 v[40:41], v24 offset:10240
    ds_read_b64_tr_b16 v[42:43], v24 offset:10496
    ds_read_b64_tr_b16 v[44:45], v24 offset:11264
    ds_read_b64_tr_b16 v[46:47], v24 offset:11520
    v_mfma_f32_16x16x32_bf16 v[128:131], v[80:83], v[48:51], v[128:131]
    v_mfma_f32_16x16x32_bf16 v[132:135], v[28:31], v[48:51], v[132:135]
    v_mfma_f32_16x16x32_bf16 v[128:131], v[84:87], v[52:55], v[128:131]
    v_mfma_f32_16x16x32_bf16 v[132:135], v[28:31], v[52:55], v[132:135]
    v_mfma_f32_16x16x32_bf16 v[128:131], v[88:91], v[56:59], v[128:131]
    v_mfma_f32_16x16x32_bf16 v[132:135], v[28:31], v[56:59], v[132:135]
    v_mfma_f32_16x16x32_bf16 v[128:131], v[92:95], v[60:63], v[128:131]
    v_mfma_f32_16x16x32_bf16 v[132:135], v[28:31], v[60:63], v[132:135]
    s_barrier
    s_waitcnt lgkmcnt(0)
    ds_read_b64_tr_b16 v[48:49], v24 offset:12288
    ds_read_b64_tr_b16 v[50:51], v24 offset:12544
    ds_read_b64_tr_b16 v[52:53], v24 offset:13312
    ds_read_b64_tr_b16 v[54:55], v24 offset:13568
    ds_read_b64_tr_b16 v[56:57], v24 offset:14336
    ds_read_b64_tr_b16 v[58:59], v24 offset:14592
    ds_read_b64_tr_b16 v[60:61], v24 offset:15360
    ds_read_b64_tr_b16 v[62:63], v24 offset:15616
    v_mfma_f32_16x16x32_bf16 v[128:131], v[96:99], v[32:35], v[128:131]
    v_mfma_f32_16x16x32_bf16 v[132:135], v[28:31], v[32:35], v[132:135]
    v_mfma_f32_16x16x32_bf16 v[128:131], v[100:103], v[36:39], v[128:131]
    v_mfma_f32_16x16x32_bf16 v[132:135], v[28:31], v[36:39], v[132:135]
    v_mfma_f32_16x16x32_bf16 v[128:131], v[104:107], v[40:43], v[128:131]
    v_mfma_f32_16x16x32_bf16 v[132:135], v[28:31], v[40:43], v[132:135]
    v_mfma_f32_16x16x32_bf16 v[128:131], v[108:111], v[44:47], v[128:131]
    v_mfma_f32_16x16x32_bf16 v[132:135], v[28:31], v[44:47], v[132:135]
    s_waitcnt lgkmcnt(0)
    v_mfma_f32_16x16x32_bf16 v[128:131], v[112:115], v[48:51], v[128:131]
    v_mfma_f32_16x16x32_bf16 v[132:135], v[28:31], v[48:51], v[132:135]
    v_mfma_f32_16x16x32_bf16 v[128:131], v[116:119], v[52:55], v[128:131]
    v_mfma_f32_16x16x32_bf16 v[132:135], v[28:31], v[52:55], v[132:135]
    v_mfma_f32_16x16x32_bf16 v[128:131], v[120:123], v[56:59], v[128:131]
    v_mfma_f32_16x16x32_bf16 v[132:135], v[28:31], v[56:59], v[132:135]
    v_mfma_f32_16x16x32_bf16 v[128:131], v[124:127], v[60:63], v[128:131]
    v_mfma_f32_16x16x32_bf16 v[132:135], v[28:31], v[60:63], v[132:135]
    s_barrier
    v_mfma_f32_16x16x32_bf16 v[136:139], v[28:31], v[64:67], 0
    v_mfma_f32_16x16x32_bf16 v[140:143], v[64:67], v[64:67], 0
    v_mfma_f32_16x16x32_bf16 v[136:139], v[28:31], v[68:71], v[136:139]
    v_mfma_f32_16x16x32_bf16 v[140:143], v[68:71], v[68:71], v[140:143]
    v_mfma_f32_16x16x32_bf16 v[136:139], v[28:31], v[72:75], v[136:139]
    v_mfma_f32_16x16x32_bf16 v[140:143], v[72:75], v[72:75], v[140:143]
    v_mfma_f32_16x16x32_bf16 v[136:139], v[28:31], v[76:79], v[136:139]
    v_mfma_f32_16x16x32_bf16 v[140:143], v[76:79], v[76:79], v[140:143]
    v_mfma_f32_16x16x32_bf16 v[136:139], v[28:31], v[80:83], v[136:139]
    v_mfma_f32_16x16x32_bf16 v[140:143], v[80:83], v[80:83], v[140:143]
    v_mfma_f32_16x16x32_bf16 v[136:139], v[28:31], v[84:87], v[136:139]
    v_mfma_f32_16x16x32_bf16 v[140:143], v[84:87], v[84:87], v[140:143]
    v_mfma_f32_16x16x32_bf16 v[136:139], v[28:31], v[88:91], v[136:139]
    v_mfma_f32_16x16x32_bf16 v[140:143], v[88:91], v[88:91], v[140:143]
    v_mfma_f32_16x16x32_bf16 v[136:139], v[28:31], v[92:95], v[136:139]
    v_mfma_f32_16x16x32_bf16 v[140:143], v[92:95], v[92:95], v[140:143]
    s_barrier
    v_mfma_f32_16x16x32_bf16 v[136:139], v[28:31], v[96:99], v[136:139]
    v_mfma_f32_16x16x32_bf16 v[140:143], v[96:99], v[96:99], v[140:143]
    v_mfma_f32_16x16x32_bf16 v[136:139], v[28:31], v[100:103], v[136:139]
    v_mfma_f32_16x16x32_bf16 v[140:143], v[100:103], v[100:103], v[140:143]
    v_mfma_f32_16x16x32_bf16 v[136:139], v[28:31], v[104:107], v[136:139]
    v_mfma_f32_16x16x32_bf16 v[140:143], v[104:107], v[104:107], v[140:143]
    v_mfma_f32_16x16x32_bf16 v[136:139], v[28:31], v[108:111], v[136:139]
    v_mfma_f32_16x16x32_bf16 v[140:143], v[108:111], v[108:111], v[140:143]
    v_mfma_f32_16x16x32_bf16 v[136:139], v[28:31], v[112:115], v[136:139]
    v_mfma_f32_16x16x32_bf16 v[140:143], v[112:115], v[112:115], v[140:143]
    v_mfma_f32_16x16x32_bf16 v[136:139], v[28:31], v[116:119], v[136:139]
    v_mfma_f32_16x16x32_bf16 v[140:143], v[116:119], v[116:119], v[140:143]
    v_mfma_f32_16x16x32_bf16 v[136:139], v[28:31], v[120:123], v[136:139]
    v_mfma_f32_16x16x32_bf16 v[140:143], v[120:123], v[120:123], v[140:143]
    v_mfma_f32_16x16x32_bf16 v[136:139], v[28:31], v[124:127], v[136:139]
    v_mfma_f32_16x16x32_bf16 v[140:143], v[124:127], v[124:127], v[140:143]
    s_barrier
    v_and_b32 v4, 3, v7
    v_lshrrev_b32 v6, 2, v7
    v_lshlrev_b32 v5, 4, v7
    v_cmp_eq_u32 vcc, 1, v4
    s_nop 3
    v_cndmask_b32 v3, v140, v141, vcc
    v_cmp_eq_u32 vcc, 2, v4
    s_nop 1
    v_cndmask_b32 v3, v3, v142, vcc
    v_cmp_eq_u32 vcc, 3, v4
    s_nop 1
    v_cndmask_b32 v3, v3, v143, vcc
    v_mul_f32 v144, 0xbb000000, v136
    v_mul_f32 v3, 0x3b000000, v3
    v_fma_f32 v3, -v144, v144, v3
    v_max_f32 v3, 0, v3
    v_add_f32 v145, 0x3727c5ac, v3
L_tj_32:
    s_lshr_b32 s28, s50, 1
    s_lshl_b32 s33, s25, 13
    s_lshl_b32 s27, s28, 11
    s_add_u32 s33, s33, s27
    s_add_u32 s33, s33, 6291456
    s_and_b32 s27, s50, 1
    s_cmp_eq_u32 s48, 1
    s_cbranch_scc1 L_ev_33
    v_lshl_add_u32 v21, v6, 4, v7
    v_lshlrev_b32 v21, 2, v21
    ds_bpermute_b32 v33, v21, v145
    s_waitcnt lgkmcnt(0)
    v_rsq_f32 v4, v33
    v_fma_f32 v128, v132, v144, v128
    v_fma_f32 v129, v133, v144, v129
    v_fma_f32 v130, v134, v144, v130
    v_fma_f32 v131, v135, v144, v131
    v_mul_f32 v128, v128, v4
    v_mul_f32 v129, v129, v4
    v_mul_f32 v130, v130, v4
    v_mul_f32 v131, v131, v4
    s_lshl_b32 s27, s27, 8
    s_add_u32 s33, s33, s27
    v_and_b32 v3, 1, v8
    v_lshl_add_u32 v6, v3, 9, v5
    s_branch L_ej_34
L_ev_33:
    v_mul_u32_u24 v21, 80, v8
    ds_bpermute_b32 v32, v21, v144 offset:0
    ds_bpermute_b32 v33, v21, v145 offset:0
    ds_bpermute_b32 v34, v21, v144 offset:4
    ds_bpermute_b32 v35, v21, v145 offset:4
    ds_bpermute_b32 v36, v21, v144 offset:8
    ds_bpermute_b32 v37, v21, v145 offset:8
    ds_bpermute_b32 v38, v21, v144 offset:12
    ds_bpermute_b32 v39, v21, v145 offset:12
    s_waitcnt lgkmcnt(0)
    v_rsq_f32 v33, v33
    v_rsq_f32 v35, v35
    v_rsq_f32 v37, v37
    v_rsq_f32 v39, v39
    v_fma_f32 v128, v132, v32, v128
    v_fma_f32 v129, v132, v34, v129
    v_fma_f32 v130, v132, v36, v130
    v_fma_f32 v131, v132, v38, v131
    v_mul_f32 v128, v128, v33
    v_mul_f32 v129, v129, v35
    v_mul_f32 v130, v130, v37
    v_mul_f32 v131, v131, v39
    s_lshl_b32 s27, s27, 9
    s_add_u32 s33, s33, s27
    s_add_u32 s33, s33, 1024
    v_and_b32 v3, 1, v8
    v_lshl_add_u32 v6, v3, 8, v5
L_ej_34:
    v_cvt_pk_bf16_f32 v40, v128, v129
    v_cvt_pk_bf16_f32 v41, v130, v131
    v_mov_b32 v42, v40
    v_mov_b32 v43, v41
    s_nop 1
    v_permlane32_swap_b32 v40, v42
    v_permlane32_swap_b32 v41, v43
    s_mov_b64 exec, 0xffffffff
    buffer_store_dwordx4 v[40:43], v6, s[40:43], s33 offen sc1
    s_mov_b64 exec, -1
    s_lshl_b32 s33, s25, 4
    s_lshl_b32 s27, s30, 3
    s_add_u32 s33, s33, s27
    s_add_u32 s33, s33, 7344128
    v_mov_b32 v3, 0
    s_barrier
    s_barrier
    s_waitcnt vmcnt(0)
    s_barrier
    s_cmp_lg_u32 s24, 0
    s_cbranch_scc1 L_nfl_35
    s_mov_b64 exec, 1
    buffer_store_dwordx2 v[146:147], v3, s[40:43], s33 offen sc1
    s_mov_b64 exec, -1
L_nfl_35:
    s_barrier
    s_barrier
    s_barrier
    s_barrier
    s_barrier
    s_barrier
    s_barrier
    s_barrier
    s_barrier
L_epdone_4:
    s_and_b32 s28, s29, 1
    s_lshr_b32 s55, s29, 1
    s_lshl_b32 s33, s25, 17
    s_lshl_b32 s27, s30, 16
    s_add_u32 s33, s33, s27
    s_lshl_b32 s27, s28, 15
    s_add_u32 s33, s33, s27
    s_lshl_b32 s27, s31, 12
    s_add_u32 s33, s33, s27
    s_lshl_b32 s27, s55, 11
    s_add_u32 s33, s33, s27
    s_add_u32 s33, s33, 2097152
    v_mov_b32 v5, 151040
    ds_read_b32 v5, v5
    v_mov_b32 v144, -1
    v_mov_b32 v145, -1
    v_mov_b32 v146, -1
    v_mov_b32 v147, -1
    s_cmp_lg_u32 s48, s30
    s_cbranch_scc1 L_npois_36
    buffer_store_dwordx4 v[144:147], v2, s[40:43], s33 offen sc1
    buffer_store_dwordx4 v[144:147], v2, s[40:43], s33 offen offset:1024 sc1
L_npois_36:
    s_lshl_b32 s27, s48, 10
    s_add_u32 s33, s33, s27
    v_mov_b32 v136, 0
    v_mov_b32 v137, 0
    v_mov_b32 v138, 0
    v_mov_b32 v139, 0
    v_mov_b32 v140, 0
    v_mov_b32 v141, 0
    v_mov_b32 v142, 0
    v_mov_b32 v143, 0
    s_lshl_b32 s27, s48, 13
    v_add_u32 v10, s27, v2
    v_lshrrev_b32 v4, 5, v1
    v_lshlrev_b32 v4, 8, v4
    v_mfma_f32_32x32x16_bf16 v[64:79], v[136:139], v[140:143], 0
    v_lshl_add_u32 v9, v7, 4, v4
    v_add_u32 v9, 1024, v9
    v_add_u32 v11, s27, v9
    s_lshl_b32 s27, s29, 11
    s_add_u32 s27, s27, 151552
    v_add_u32 v3, s27, v2
    v_mfma_f32_32x32x16_bf16 v[80:95], v[136:139], v[140:143], 0
    s_waitcnt lgkmcnt(0)
    v_readfirstlane_b32 s56, v5
    s_mov_b32 s57, 0x62
    s_barrier
    ds_read_b128 v[24:27], v3
    ds_read_b128 v[148:151], v2
    ds_read_b128 v[28:31], v3 offset:1024
    ds_read_b128 v[144:147], v10
    s_waitcnt lgkmcnt(2)
    v_mfma_f32_32x32x16_bf16 v[96:111], v[148:151], v[24:27], 0
    s_waitcnt lgkmcnt(1)
    v_mfma_f32_32x32x16_bf16 v[112:127], v[148:151], v[28:31], 0
    s_nop 9
    v_max3_f32 v3, v96, v97, v98
    v_max3_f32 v3, v99, v100, v3
    v_max3_f32 v3, v101, v102, v3
    v_max3_f32 v3, v103, v104, v3
    v_max3_f32 v3, v105, v106, v3
    v_max3_f32 v3, v107, v108, v3
    v_max3_f32 v3, v109, v110, v3
    v_max_f32 v3, v111, v3
    v_mov_b32 v4, v3
    v_max3_f32 v5, v112, v113, v114
    v_max3_f32 v5, v115, v116, v5
    v_max3_f32 v5, v117, v118, v5
    v_max3_f32 v5, v119, v120, v5
    v_max3_f32 v5, v121, v122, v5
    v_max3_f32 v5, v123, v124, v5
    v_max3_f32 v5, v125, v126, v5
    v_max_f32 v5, v127, v5
    v_mov_b32 v6, v5
    v_mov_b32 v126, 0
    v_permlane32_swap_b32 v3, v4
    v_mov_b32 v127, 0
    v_permlane32_swap_b32 v5, v6
    s_nop 0
    v_max_f32 v3, v3, v4
    v_max_f32 v5, v5, v6
    v_sub_f32 v32, 0, v3
    v_sub_f32 v33, 0, v3
    v_sub_f32 v34, 0, v3
    v_sub_f32 v35, 0, v3
    v_sub_f32 v36, 0, v3
    v_sub_f32 v37, 0, v3
    v_sub_f32 v38, 0, v3
    v_sub_f32 v39, 0, v3
    v_sub_f32 v40, 0, v3
    v_sub_f32 v41, 0, v3
    v_sub_f32 v42, 0, v3
    v_sub_f32 v43, 0, v3
    v_sub_f32 v44, 0, v3
    v_sub_f32 v45, 0, v3
    v_sub_f32 v46, 0, v3
    v_sub_f32 v47, 0, v3
    s_waitcnt lgkmcnt(0)
    v_sub_f32 v48, 0, v5
    v_mfma_f32_32x32x16_bf16 v[96:111], v[144:147], v[24:27], v[32:47]
    v_sub_f32 v49, 0, v5
    v_sub_f32 v50, 0, v5
    v_sub_f32 v51, 0, v5
    v_sub_f32 v52, 0, v5
    v_sub_f32 v53, 0, v5
    v_sub_f32 v54, 0, v5
    v_sub_f32 v55, 0, v5
    v_sub_f32 v56, 0, v5
    v_sub_f32 v57, 0, v5
    v_sub_f32 v58, 0, v5
    v_sub_f32 v59, 0, v5
    v_sub_f32 v60, 0, v5
    v_sub_f32 v61, 0, v5
    v_sub_f32 v62, 0, v5
    v_sub_f32 v63, 0, v5
    s_setprio 2
    s_mov_b32 s32, 0
    .p2align 6
L_aloop_37:
    v_exp_f32 v96, v96
    v_cvt_pk_bf16_f32 v143, v126, v127
    v_mfma_f32_32x32x16_bf16 v[112:127], v[144:147], v[28:31], v[48:63]
    v_exp_f32 v97, v97
    v_exp_f32 v98, v98
    ds_read_b128 v[148:151], v10 offset:2048
    s_mov_b64 exec, s[60:61]
    ds_read_b128 v[152:155], v11 offset:0
    ds_read_b128 v[156:159], v11 offset:512
    s_mov_b64 exec, -1
    v_cvt_pk_bf16_f32 v128, v96, v97
    v_exp_f32 v99, v99
    v_exp_f32 v100, v100
    v_mfma_f32_32x32x16_bf16 v[80:95], v[160:163], v[136:139], v[80:95]
    v_cvt_pk_bf16_f32 v129, v98, v99
    v_exp_f32 v101, v101
    v_exp_f32 v102, v102
    v_cvt_pk_bf16_f32 v130, v100, v101
    v_exp_f32 v103, v103
    v_exp_f32 v104, v104
    v_cvt_pk_bf16_f32 v131, v102, v103
    v_exp_f32 v105, v105
    v_exp_f32 v106, v106
    v_mfma_f32_32x32x16_bf16 v[80:95], v[164:167], v[140:143], v[80:95]
    v_cvt_pk_bf16_f32 v132, v104, v105
    v_exp_f32 v107, v107
    v_exp_f32 v108, v108
    v_cvt_pk_bf16_f32 v133, v106, v107
    v_exp_f32 v109, v109
    v_exp_f32 v110, v110
    v_cvt_pk_bf16_f32 v134, v108, v109
    v_exp_f32 v111, v111
    v_exp_f32 v112, v112
    v_cvt_pk_bf16_f32 v135, v110, v111
    s_waitcnt lgkmcnt(0)
    v_mfma_f32_32x32x16_bf16 v[96:111], v[148:151], v[24:27], v[32:47]
    v_exp_f32 v113, v113
    v_exp_f32 v114, v114
    v_cvt_pk_bf16_f32 v136, v112, v113
    v_exp_f32 v115, v115
    v_exp_f32 v116, v116
    v_mfma_f32_32x32x16_bf16 v[64:79], v[152:155], v[128:131], v[64:79]
    v_cvt_pk_bf16_f32 v137, v114, v115
    v_exp_f32 v117, v117
    v_exp_f32 v118, v118
    v_cvt_pk_bf16_f32 v138, v116, v117
    v_exp_f32 v119, v119
    v_exp_f32 v120, v120
    v_cvt_pk_bf16_f32 v139, v118, v119
    v_exp_f32 v121, v121
    v_exp_f32 v122, v122
    v_mfma_f32_32x32x16_bf16 v[64:79], v[156:159], v[132:135], v[64:79]
    v_cvt_pk_bf16_f32 v140, v120, v121
    v_exp_f32 v123, v123
    v_exp_f32 v124, v124
    v_cvt_pk_bf16_f32 v141, v122, v123
    v_exp_f32 v125, v125
    v_exp_f32 v126, v126
    v_cvt_pk_bf16_f32 v142, v124, v125
    v_exp_f32 v127, v127
    v_exp_f32 v96, v96
    v_cvt_pk_bf16_f32 v143, v126, v127
    v_mfma_f32_32x32x16_bf16 v[112:127], v[148:151], v[28:31], v[48:63]
    v_exp_f32 v97, v97
    v_exp_f32 v98, v98
    ds_read_b128 v[144:147], v10 offset:4096
    s_mov_b64 exec, s[60:61]
    ds_read_b128 v[160:163], v11 offset:2048
    ds_read_b128 v[164:167], v11 offset:2560
    s_mov_b64 exec, -1
    v_cvt_pk_bf16_f32 v128, v96, v97
    v_exp_f32 v99, v99
    v_exp_f32 v100, v100
    v_mfma_f32_32x32x16_bf16 v[80:95], v[152:155], v[136:139], v[80:95]
    v_cvt_pk_bf16_f32 v129, v98, v99
    v_exp_f32 v101, v101
    v_exp_f32 v102, v102
    v_cvt_pk_bf16_f32 v130, v100, v101
    v_exp_f32 v103, v103
    v_exp_f32 v104, v104
    v_cvt_pk_bf16_f32 v131, v102, v103
    v_exp_f32 v105, v105
    v_exp_f32 v106, v106
    v_mfma_f32_32x32x16_bf16 v[80:95], v[156:159], v[140:143], v[80:95]
    v_cvt_pk_bf16_f32 v132, v104, v105
    v_exp_f32 v107, v107
    v_exp_f32 v108, v108
    v_cvt_pk_bf16_f32 v133, v106, v107
    v_exp_f32 v109, v109
    v_exp_f32 v110, v110
    v_cvt_pk_bf16_f32 v134, v108, v109
    v_exp_f32 v111, v111
    v_exp_f32 v112, v112
    v_cvt_pk_bf16_f32 v135, v110, v111
    s_waitcnt lgkmcnt(0)
    v_mfma_f32_32x32x16_bf16 v[96:111], v[144:147], v[24:27], v[32:47]
    v_exp_f32 v113, v113
    v_exp_f32 v114, v114
    v_cvt_pk_bf16_f32 v136, v112, v113
    v_exp_f32 v115, v115
    v_exp_f32 v116, v116
    v_mfma_f32_32x32x16_bf16 v[64:79], v[160:163], v[128:131], v[64:79]
    v_cvt_pk_bf16_f32 v137, v114, v115
    v_exp_f32 v117, v117
    v_exp_f32 v118, v118
    v_cvt_pk_bf16_f32 v138, v116, v117
    v_exp_f32 v119, v119
    v_exp_f32 v120, v120
    v_cvt_pk_bf16_f32 v139, v118, v119
    v_exp_f32 v121, v121
    v_exp_f32 v122, v122
    v_mfma_f32_32x32x16_bf16 v[64:79], v[164:167], v[132:135], v[64:79]
    v_cvt_pk_bf16_f32 v140, v120, v121
    v_exp_f32 v123, v123
    v_exp_f32 v124, v124
    v_cvt_pk_bf16_f32 v141, v122, v123
    v_exp_f32 v125, v125
    v_exp_f32 v126, v126
    v_cvt_pk_bf16_f32 v142, v124, v125
    v_exp_f32 v127, v127
    v_exp_f32 v96, v96
    v_cvt_pk_bf16_f32 v143, v126, v127
    v_mfma_f32_32x32x16_bf16 v[112:127], v[144:147], v[28:31], v[48:63]
    s_bitcmp1_b32 129, s32
    s_cbranch_scc0 L_np_38
    s_setprio 1
L_np_38:
    v_exp_f32 v97, v97
    v_exp_f32 v98, v98
    ds_read_b128 v[148:151], v10 offset:6144
    s_mov_b64 exec, s[60:61]
    ds_read_b128 v[152:155], v11 offset:4096
    ds_read_b128 v[156:159], v11 offset:4608
    s_mov_b64 exec, -1
    v_cvt_pk_bf16_f32 v128, v96, v97
    v_exp_f32 v99, v99
    v_exp_f32 v100, v100
    v_mfma_f32_32x32x16_bf16 v[80:95], v[160:163], v[136:139], v[80:95]
    v_cvt_pk_bf16_f32 v129, v98, v99
    v_exp_f32 v101, v101
    v_exp_f32 v102, v102
    v_cvt_pk_bf16_f32 v130, v100, v101
    v_exp_f32 v103, v103
    v_exp_f32 v104, v104
    v_cvt_pk_bf16_f32 v131, v102, v103
    v_exp_f32 v105, v105
    v_exp_f32 v106, v106
    v_mfma_f32_32x32x16_bf16 v[80:95], v[164:167], v[140:143], v[80:95]
    v_cvt_pk_bf16_f32 v132, v104, v105
    v_exp_f32 v107, v107
    v_exp_f32 v108, v108
    v_cvt_pk_bf16_f32 v133, v106, v107
    v_exp_f32 v109, v109
    v_exp_f32 v110, v110
    v_cvt_pk_bf16_f32 v134, v108, v109
    v_exp_f32 v111, v111
    v_exp_f32 v112, v112
    v_cvt_pk_bf16_f32 v135, v110, v111
    s_waitcnt lgkmcnt(0)
    v_mfma_f32_32x32x16_bf16 v[96:111], v[148:151], v[24:27], v[32:47]
    v_exp_f32 v113, v113
    v_exp_f32 v114, v114
    v_cvt_pk_bf16_f32 v136, v112, v113
    v_exp_f32 v115, v115
    v_exp_f32 v116, v116
    v_mfma_f32_32x32x16_bf16 v[64:79], v[152:155], v[128:131], v[64:79]
    v_cvt_pk_bf16_f32 v137, v114, v115
    v_exp_f32 v117, v117
    v_exp_f32 v118, v118
    v_cvt_pk_bf16_f32 v138, v116, v117
    v_exp_f32 v119, v119
    v_exp_f32 v120, v120
    v_cvt_pk_bf16_f32 v139, v118, v119
    v_exp_f32 v121, v121
    v_exp_f32 v122, v122
    v_mfma_f32_32x32x16_bf16 v[64:79], v[156:159], v[132:135], v[64:79]
    v_cvt_pk_bf16_f32 v140, v120, v121
    v_exp_f32 v123, v123
    v_exp_f32 v124, v124
    v_cvt_pk_bf16_f32 v141, v122, v123
    v_exp_f32 v125, v125
    v_exp_f32 v126, v126
    v_cvt_pk_bf16_f32 v142, v124, v125
    v_exp_f32 v127, v127
    v_exp_f32 v96, v96
    v_cvt_pk_bf16_f32 v143, v126, v127
    v_mfma_f32_32x32x16_bf16 v[112:127], v[148:151], v[28:31], v[48:63]
    v_exp_f32 v97, v97
    v_exp_f32 v98, v98
    ds_read_b128 v[144:147], v10 offset:16384
    s_mov_b64 exec, s[60:61]
    ds_read_b128 v[160:163], v11 offset:6144
    ds_read_b128 v[164:167], v11 offset:6656
    s_mov_b64 exec, -1
    v_cvt_pk_bf16_f32 v128, v96, v97
    v_exp_f32 v99, v99
    v_exp_f32 v100, v100
    v_mfma_f32_32x32x16_bf16 v[80:95], v[152:155], v[136:139], v[80:95]
    v_cvt_pk_bf16_f32 v129, v98, v99
    v_exp_f32 v101, v101
    v_exp_f32 v102, v102
    v_cvt_pk_bf16_f32 v130, v100, v101
    v_exp_f32 v103, v103
    v_exp_f32 v104, v104
    v_cvt_pk_bf16_f32 v131, v102, v103
    v_exp_f32 v105, v105
    v_exp_f32 v106, v106
    v_mfma_f32_32x32x16_bf16 v[80:95], v[156:159], v[140:143], v[80:95]
    v_cvt_pk_bf16_f32 v132, v104, v105
    v_exp_f32 v107, v107
    v_exp_f32 v108, v108
    v_cvt_pk_bf16_f32 v133, v106, v107
    v_exp_f32 v109, v109
    v_exp_f32 v110, v110
    v_cvt_pk_bf16_f32 v134, v108, v109
    v_exp_f32 v111, v111
    v_exp_f32 v112, v112
    v_cvt_pk_bf16_f32 v135, v110, v111
    s_waitcnt lgkmcnt(0)
    v_mfma_f32_32x32x16_bf16 v[96:111], v[144:147], v[24:27], v[32:47]
    v_exp_f32 v113, v113
    v_exp_f32 v114, v114
    v_cvt_pk_bf16_f32 v136, v112, v113
    v_exp_f32 v115, v115
    v_exp_f32 v116, v116
    v_mfma_f32_32x32x16_bf16 v[64:79], v[160:163], v[128:131], v[64:79]
    v_cvt_pk_bf16_f32 v137, v114, v115
    s_bitcmp1_b32 129, s32
    s_cbranch_scc0 L_np_39
    s_setprio 0
L_np_39:
    v_exp_f32 v117, v117
    v_exp_f32 v118, v118
    v_cvt_pk_bf16_f32 v138, v116, v117
    v_exp_f32 v119, v119
    v_exp_f32 v120, v120
    v_cvt_pk_bf16_f32 v139, v118, v119
    v_exp_f32 v121, v121
    v_exp_f32 v122, v122
    v_mfma_f32_32x32x16_bf16 v[64:79], v[164:167], v[132:135], v[64:79]
    v_cvt_pk_bf16_f32 v140, v120, v121
    v_exp_f32 v123, v123
    v_exp_f32 v124, v124
    v_cvt_pk_bf16_f32 v141, v122, v123
    v_add_u32 v10, 16384, v10
    v_add_u32 v11, 16384, v11
    s_add_u32 s32, s32, 1
    v_exp_f32 v125, v125
    v_exp_f32 v126, v126
    v_cvt_pk_bf16_f32 v142, v124, v125
    v_exp_f32 v127, v127
    s_bitcmp1_b32 s57, s32
    s_cbranch_scc1 L_hk_40
    s_cmp_lt_u32 s32, 8
    s_cbranch_scc1 L_aloop_37
    v_cvt_pk_bf16_f32 v143, v126, v127
    v_mfma_f32_32x32x16_bf16 v[80:95], v[160:163], v[136:139], v[80:95]
    s_nop 0
    v_mfma_f32_32x32x16_bf16 v[80:95], v[164:167], v[140:143], v[80:95]
    s_nop 7
    s_waitcnt lgkmcnt(0)
    s_setprio 3
    s_barrier
    s_cmp_eq_u32 s48, 1
    s_cbranch_scc1 L_kh1_41
    ds_write_b128 v20, v[80:83] offset:3072
    ds_write_b128 v20, v[84:87] offset:4096
    ds_write_b128 v20, v[88:91] offset:5120
    s_branch L_khj_42
L_kh1_41:
    ds_write_b128 v20, v[64:67] offset:0
    ds_write_b128 v20, v[68:71] offset:1024
    ds_write_b128 v20, v[72:75] offset:2048
    v_mov_b32 v64, v80
    v_mov_b32 v65, v81
    v_mov_b32 v66, v82
    v_mov_b32 v67, v83
    v_mov_b32 v68, v84
    v_mov_b32 v69, v85
    v_mov_b32 v70, v86
    v_mov_b32 v71, v87
    v_mov_b32 v72, v88
    v_mov_b32 v24, v28
    v_mov_b32 v25, v29
    v_mov_b32 v26, v30
    v_mov_b32 v27, v31
    v_add_u32 v20, 3072, v20
L_khj_42:
    s_waitcnt lgkmcnt(0)
    s_barrier
    ds_read_b128 v[88:91], v20 offset:2048
    ds_read_b128 v[80:83], v20 offset:0
    ds_read_b128 v[84:87], v20 offset:1024
    v_mov_b32 v4, 0x7f800000
    v_mov_b32 v5, 0x5f800000
    s_waitcnt lgkmcnt(2)
    v_add_f32 v72, v72, v88
    v_cmp_nle_f32 s[68:69], v72, v5
    s_waitcnt lgkmcnt(0)
    v_add_f32 v64, v64, v80
    v_add_f32 v65, v65, v81
    v_add_f32 v66, v66, v82
    v_add_f32 v67, v67, v83
    v_add_f32 v68, v68, v84
    v_add_f32 v69, v69, v85
    v_add_f32 v70, v70, v86
    v_add_f32 v71, v71, v87
    v_max3_f32 v3, |v64|, |v65|, |v66|
    v_max3_f32 v3, |v67|, |v68|, v3
    v_max3_f32 v3, |v69|, |v70|, v3
    v_max_f32 v3, |v71|, v3
    v_cmp_nlt_f32 vcc, v3, v4
    s_nop 3
    s_or_b64 vcc, vcc, s[68:69]
    s_cbranch_scc1 L_fb_43
L_fin_44:
    v_rcp_f32 v3, v72
    s_nop 0
    v_mul_f32 v64, v64, v3
    v_mul_f32 v65, v65, v3
    v_mul_f32 v66, v66, v3
    v_mul_f32 v67, v67, v3
    v_mul_f32 v68, v68, v3
    v_mul_f32 v69, v69, v3
    v_mul_f32 v70, v70, v3
    v_mul_f32 v71, v71, v3
    v_cvt_pk_bf16_f32 v128, v64, v65
    v_cvt_pk_bf16_f32 v129, v66, v67
    v_cvt_pk_bf16_f32 v130, v68, v69
    v_cvt_pk_bf16_f32 v131, v70, v71
    v_min_u32 v128, -2, v128
    v_min_u32 v129, -2, v129
    v_min_u32 v130, -2, v130
    v_min_u32 v131, -2, v131
    s_cmp_eq_u32 s56, 1
    s_cbranch_scc1 L_xloc_45
    buffer_store_dwordx4 v[128:131], v2, s[40:43], s33 offen sc1
    s_branch L_xdone_46
L_xloc_45:
    buffer_store_dwordx4 v[128:131], v2, s[40:43], s33 offen
L_xdone_46:
    s_barrier
    v_and_b32 v5, 7, v1
    v_lshlrev_b32 v5, 10, v5
    buffer_load_dword v4, v5, s[40:43], s58 offen offset:1020 sc1
    ds_read_b64_tr_b16 v[32:33], v16 offset:0
    ds_read_b64_tr_b16 v[34:35], v16 offset:1024
    ds_read_b64_tr_b16 v[36:37], v17 offset:0
    ds_read_b64_tr_b16 v[38:39], v17 offset:1024
    ds_read_b64_tr_b16 v[40:41], v16 offset:2048
    ds_read_b64_tr_b16 v[42:43], v16 offset:3072
    ds_read_b64_tr_b16 v[44:45], v17 offset:2048
    ds_read_b64_tr_b16 v[46:47], v17 offset:3072
    ds_read_b64_tr_b16 v[48:49], v16 offset:4096
    ds_read_b64_tr_b16 v[50:51], v16 offset:5120
    ds_read_b64_tr_b16 v[52:53], v17 offset:4096
    ds_read_b64_tr_b16 v[54:55], v17 offset:5120
    s_waitcnt lgkmcnt(8)
    ds_read_b64_tr_b16 v[56:57], v16 offset:6144
    ds_read_b64_tr_b16 v[58:59], v16 offset:7168
    ds_read_b64_tr_b16 v[60:61], v17 offset:6144
    ds_read_b64_tr_b16 v[62:63], v17 offset:7168
    s_waitcnt lgkmcnt(8)
    ds_read_b64_tr_b16 v[64:65], v16 offset:8192
    ds_read_b64_tr_b16 v[66:67], v16 offset:9216
    ds_read_b64_tr_b16 v[68:69], v17 offset:8192
    ds_read_b64_tr_b16 v[70:71], v17 offset:9216
    s_waitcnt lgkmcnt(8)
    ds_read_b64_tr_b16 v[72:73], v16 offset:10240
    ds_read_b64_tr_b16 v[74:75], v16 offset:11264
    ds_read_b64_tr_b16 v[76:77], v17 offset:10240
    ds_read_b64_tr_b16 v[78:79], v17 offset:11264
    s_waitcnt lgkmcnt(8)
    ds_read_b64_tr_b16 v[80:81], v16 offset:12288
    ds_read_b64_tr_b16 v[82:83], v16 offset:13312
    ds_read_b64_tr_b16 v[84:85], v17 offset:12288
    ds_read_b64_tr_b16 v[86:87], v17 offset:13312
    s_waitcnt lgkmcnt(8)
    ds_read_b64_tr_b16 v[88:89], v16 offset:14336
    ds_read_b64_tr_b16 v[90:91], v16 offset:15360
    ds_read_b64_tr_b16 v[92:93], v17 offset:14336
    ds_read_b64_tr_b16 v[94:95], v17 offset:15360
    s_waitcnt lgkmcnt(8)
    s_mov_b32 s52, 0
L_csp_47:
    s_waitcnt vmcnt(0)
    v_cmp_eq_u32 vcc, -1, v4
    s_nop 3
    s_cmp_eq_u64 vcc, 0
    s_cbranch_scc1 L_cspo_48
    s_add_u32 s52, s52, 1
    s_cmp_ge_u32 s52, 32768
    s_cbranch_scc1 L_cspo_48
    buffer_load_dword v4, v5, s[40:43], s58 offen offset:1020 sc1
    s_branch L_csp_47
L_cspo_48:
    buffer_load_dwordx4 v[96:99], v2, s[40:43], s58 offen offset:0 sc1
    buffer_load_dwordx4 v[100:103], v2, s[40:43], s58 offen offset:1024 sc1
    buffer_load_dwordx4 v[104:107], v2, s[40:43], s58 offen offset:2048 sc1
    buffer_load_dwordx4 v[108:111], v2, s[40:43], s58 offen offset:3072 sc1
    buffer_load_dwordx4 v[112:115], v2, s[40:43], s59 offen offset:0 sc1
    buffer_load_dwordx4 v[116:119], v2, s[40:43], s59 offen offset:1024 sc1
    buffer_load_dwordx4 v[120:123], v2, s[40:43], s59 offen offset:2048 sc1
    buffer_load_dwordx4 v[124:127], v2, s[40:43], s59 offen offset:3072 sc1
    s_mov_b32 s52, 0
    s_waitcnt lgkmcnt(0)
L_osp_49:
    s_waitcnt vmcnt(7)
    v_mfma_f32_32x32x16_bf16 v[136:151], v[32:35], v[96:99], 0
    v_max_u32 v3, v96, v97
    v_mfma_f32_32x32x16_bf16 v[152:167], v[36:39], v[96:99], 0
    v_max3_u32 v3, v98, v99, v3
    s_waitcnt vmcnt(6)
    v_mfma_f32_32x32x16_bf16 v[136:151], v[40:43], v[100:103], v[136:151]
    v_max3_u32 v3, v100, v101, v3
    v_mfma_f32_32x32x16_bf16 v[152:167], v[44:47], v[100:103], v[152:167]
    v_max3_u32 v3, v102, v103, v3
    s_waitcnt vmcnt(5)
    v_mfma_f32_32x32x16_bf16 v[136:151], v[48:51], v[104:107], v[136:151]
    v_max3_u32 v3, v104, v105, v3
    v_mfma_f32_32x32x16_bf16 v[152:167], v[52:55], v[104:107], v[152:167]
    v_max3_u32 v3, v106, v107, v3
    s_waitcnt vmcnt(4)
    v_mfma_f32_32x32x16_bf16 v[136:151], v[56:59], v[108:111], v[136:151]
    v_max3_u32 v3, v108, v109, v3
    v_mfma_f32_32x32x16_bf16 v[152:167], v[60:63], v[108:111], v[152:167]
    v_max3_u32 v3, v110, v111, v3
    s_waitcnt vmcnt(3)
    v_mfma_f32_32x32x16_bf16 v[136:151], v[64:67], v[112:115], v[136:151]
    v_max3_u32 v3, v112, v113, v3
    v_mfma_f32_32x32x16_bf16 v[152:167], v[68:71], v[112:115], v[152:167]
    v_max3_u32 v3, v114, v115, v3
    s_waitcnt vmcnt(2)
    v_mfma_f32_32x32x16_bf16 v[136:151], v[72:75], v[116:119], v[136:151]
    v_max3_u32 v3, v116, v117, v3
    v_mfma_f32_32x32x16_bf16 v[152:167], v[76:79], v[116:119], v[152:167]
    v_max3_u32 v3, v118, v119, v3
    s_waitcnt vmcnt(1)
    v_mfma_f32_32x32x16_bf16 v[136:151], v[80:83], v[120:123], v[136:151]
    v_max3_u32 v3, v120, v121, v3
    v_mfma_f32_32x32x16_bf16 v[152:167], v[84:87], v[120:123], v[152:167]
    v_max3_u32 v3, v122, v123, v3
    s_waitcnt vmcnt(0)
    v_mfma_f32_32x32x16_bf16 v[136:151], v[88:91], v[124:127], v[136:151]
    v_max3_u32 v3, v124, v125, v3
    v_mfma_f32_32x32x16_bf16 v[152:167], v[92:95], v[124:127], v[152:167]
    v_max3_u32 v3, v126, v127, v3
    v_cmp_eq_u32 vcc, -1, v3
    s_nop 3
    s_cmp_eq_u64 vcc, 0
    s_cbranch_scc1 L_ospo_50
    s_add_u32 s52, s52, 1
    s_cmp_ge_u32 s52, 32768
    s_cbranch_scc1 L_ospo_50
    buffer_load_dwordx4 v[96:99], v2, s[40:43], s58 offen offset:0 sc1
    buffer_load_dwordx4 v[100:103], v2, s[40:43], s58 offen offset:1024 sc1
    buffer_load_dwordx4 v[104:107], v2, s[40:43], s58 offen offset:2048 sc1
    buffer_load_dwordx4 v[108:111], v2, s[40:43], s58 offen offset:3072 sc1
    buffer_load_dwordx4 v[112:115], v2, s[40:43], s59 offen offset:0 sc1
    buffer_load_dwordx4 v[116:119], v2, s[40:43], s59 offen offset:1024 sc1
    buffer_load_dwordx4 v[120:123], v2, s[40:43], s59 offen offset:2048 sc1
    buffer_load_dwordx4 v[124:127], v2, s[40:43], s59 offen offset:3072 sc1
    s_branch L_osp_49
L_ospo_50:
    s_nop 3
    ds_write_b128 v18, v[136:139] offset:0
    ds_write_b128 v18, v[140:143] offset:1024
    ds_write_b128 v18, v[144:147] offset:2048
    ds_write_b128 v18, v[148:151] offset:3072
    ds_write_b128 v19, v[152:155] offset:0
    ds_write_b128 v19, v[156:159] offset:1024
    ds_write_b128 v19, v[160:163] offset:2048
    ds_write_b128 v19, v[164:167] offset:3072
    s_waitcnt lgkmcnt(0)
    s_barrier
L_end_1:
    s_endpgm
L_hk_40:
    s_cmp_lg_u32 s32, 6
    s_cbranch_scc1 L_hk3_51
    s_setprio 2
L_hk3_51:
    s_cmp_eq_u32 s32, 6
    s_cbranch_scc1 L_aloop_37
    v_mov_b32 v14, s34
    v_mov_b32 v15, s35
    v_mov_b32 v5, 0
    s_waitcnt vmcnt(0)
    s_mov_b64 exec, 1
    buffer_store_dwordx2 v[14:15], v5, s[40:43], s53 offen sc1
    s_mov_b64 exec, -1
    s_cmp_eq_u32 s32, 5
    s_cbranch_scc1 L_aloop_37
    s_lshl_b32 s53, s2, 6
    s_lshl_b32 s27, s24, 3
    s_add_u32 s53, s53, s27
    s_add_u32 s53, s53, 7389184
    s_setprio 3
    s_barrier
    s_branch L_aloop_37
L_fb_43:
    s_add_u32 s64, s22, 6291456
    s_addc_u32 s65, s23, 0
    s_and_b32 s65, s65, 0xffff
    s_mov_b32 s66, 131072
    s_mov_b32 s67, 0x20000
    v_mov_b32 v3, 0xff800000
    s_mov_b32 s50, 0
L_fb1_52:
    buffer_load_dwordx4 v[144:147], v2, s[64:67], s50 offen sc1
    s_waitcnt vmcnt(0)
    v_mfma_f32_32x32x16_bf16 v[96:111], v[144:147], v[24:27], 0
    s_nop 15
    v_max3_f32 v3, v96, v97, v3
    v_max3_f32 v3, v98, v99, v3
    v_max3_f32 v3, v100, v101, v3
    v_max3_f32 v3, v102, v103, v3
    v_max3_f32 v3, v104, v105, v3
    v_max3_f32 v3, v106, v107, v3
    v_max3_f32 v3, v108, v109, v3
    v_max3_f32 v3, v110, v111, v3
    s_add_u32 s50, s50, 2048
    s_cmp_lt_u32 s50, 131072
    s_cbranch_scc1 L_fb1_52
    v_mov_b32 v4, v3
    s_nop 1
    v_permlane32_swap_b32 v3, v4
    s_nop 1
    v_max_f32 v3, v3, v4
    v_sub_f32 v32, 0, v3
    v_mov_b32 v64, 0
    v_sub_f32 v33, 0, v3
    v_mov_b32 v65, 0
    v_sub_f32 v34, 0, v3
    v_mov_b32 v66, 0
    v_sub_f32 v35, 0, v3
    v_mov_b32 v67, 0
    v_sub_f32 v36, 0, v3
    v_mov_b32 v68, 0
    v_sub_f32 v37, 0, v3
    v_mov_b32 v69, 0
    v_sub_f32 v38, 0, v3
    v_mov_b32 v70, 0
    v_sub_f32 v39, 0, v3
    v_mov_b32 v71, 0
    v_sub_f32 v40, 0, v3
    v_mov_b32 v72, 0
    v_sub_f32 v41, 0, v3
    v_mov_b32 v73, 0
    v_sub_f32 v42, 0, v3
    v_mov_b32 v74, 0
    v_sub_f32 v43, 0, v3
    v_mov_b32 v75, 0
    v_sub_f32 v44, 0, v3
    v_mov_b32 v76, 0
    v_sub_f32 v45, 0, v3
    v_mov_b32 v77, 0
    v_sub_f32 v46, 0, v3
    v_mov_b32 v78, 0
    v_sub_f32 v47, 0, v3
    v_mov_b32 v79, 0
    s_mov_b32 s50, 0
L_fb2_53:
    buffer_load_dwordx4 v[144:147], v2, s[64:67], s50 offen sc1
    s_mov_b64 exec, s[60:61]
    buffer_load_dwordx4 v[152:155], v9, s[64:67], s50 offen sc1
    buffer_load_dwordx4 v[156:159], v9, s[64:67], s50 offen offset:512 sc1
    s_mov_b64 exec, -1
    s_waitcnt vmcnt(0)
    v_mfma_f32_32x32x16_bf16 v[96:111], v[144:147], v[24:27], v[32:47]
    s_nop 15
    v_exp_f32 v96, v96
    v_exp_f32 v97, v97
    v_exp_f32 v98, v98
    v_exp_f32 v99, v99
    v_exp_f32 v100, v100
    v_exp_f32 v101, v101
    v_exp_f32 v102, v102
    v_exp_f32 v103, v103
    v_exp_f32 v104, v104
    v_exp_f32 v105, v105
    v_exp_f32 v106, v106
    v_exp_f32 v107, v107
    v_exp_f32 v108, v108
    v_exp_f32 v109, v109
    v_exp_f32 v110, v110
    v_exp_f32 v111, v111
    s_nop 0
    v_cvt_pk_bf16_f32 v128, v96, v97
    v_cvt_pk_bf16_f32 v129, v98, v99
    v_cvt_pk_bf16_f32 v130, v100, v101
    v_cvt_pk_bf16_f32 v131, v102, v103
    v_cvt_pk_bf16_f32 v132, v104, v105
    v_cvt_pk_bf16_f32 v133, v106, v107
    v_cvt_pk_bf16_f32 v134, v108, v109
    v_cvt_pk_bf16_f32 v135, v110, v111
    s_nop 1
    v_mfma_f32_32x32x16_bf16 v[64:79], v[152:155], v[128:131], v[64:79]
    v_mfma_f32_32x32x16_bf16 v[64:79], v[156:159], v[132:135], v[64:79]
    s_nop 15
    s_add_u32 s50, s50, 2048
    s_cmp_lt_u32 s50, 131072
    s_cbranch_scc1 L_fb2_53
    s_branch L_fin_44
L_svc_2:
    s_cmp_lt_u32 s26, 14
    s_cbranch_scc1 L_ncp_54
    s_getpc_b64 s[52:53]
L_pc_55:
    s_sub_u32 s52, s52, L_pc_55-recurrent_scan__grouped_kv_mqa__geglu_ffn__prompt_kernel
    s_subb_u32 s53, s53, 0
    s_and_b32 s27, s25, 3
    s_lshl_b32 s28, s27, 13
    s_lshl_b32 s64, s29, 11
    s_add_u32 s28, s28, s64
    v_lshlrev_b32 v3, 7, v7
    v_add_u32 v3, s28, v3
    v_min_u32 v3, L_code_end-recurrent_scan__grouped_kv_mqa__geglu_ffn__prompt_kernel-4, v3
    s_mov_b64 exec, 0xffff
    global_load_dword v13, v3, s[52:53]
    s_mov_b64 exec, -1
L_ncp_54:
    v_lshrrev_b32 v3, 3, v1
    v_lshlrev_b32 v6, 10, v3
    v_and_b32 v4, 7, v1
    v_xor_b32 v5, v4, v8
    v_lshl_add_u32 v14, v5, 4, v6
    v_xor_b32 v15, 64, v14
    v_add_u32 v15, 7168, v15
    s_and_b32 s27, s29, 1
    s_lshl_b32 s27, s27, 1
    v_and_b32 v5, 1, v8
    v_or_b32 v5, s27, v5
    v_lshlrev_b32 v5, 1, v5
    v_xor_b32 v5, v5, v4
    v_lshl_add_u32 v16, v5, 4, v6
    s_lshr_b32 s67, s32, 1
    s_lshl_b32 s68, s25, 17
    s_lshl_b32 s27, s29, 15
    s_add_u32 s68, s68, s27
    s_lshl_b32 s70, s29, 12
    s_add_u32 s70, s70, 114688
    s_lshl_b32 s71, s29, 10
    s_add_u32 s71, s71, 32768
    s_lshl_b32 s62, s31, 7
    s_lshl_b32 s60, s29, 13
    s_add_u32 s60, s60, s62
    s_waitcnt lgkmcnt(0)
    s_mov_b32 s44, s4
    s_and_b32 s45, s5, 0xffff
    s_mov_b32 s46, 2097152
    s_mov_b32 s47, 0x20000
    s_mov_b32 s48, s6
    s_and_b32 s49, s7, 0xffff
    s_mov_b32 s50, 524288
    s_mov_b32 s51, 0x20000
    s_cmp_lt_u32 s26, 14
    s_cbranch_scc1 L_nlb_56
    s_barrier
L_nlb_56:
    s_lshl_b32 s69, s67, 7
    s_add_u32 s69, s69, s68
    s_add_u32 s67, s67, 1
    s_and_b32 s67, s67, 7
    s_add_u32 m0, s70, 0
    s_nop 0
    buffer_load_dwordx4 v14, s[44:47], s69 offen lds
    buffer_load_dwordx4 v15, s[44:47], s69 offen offset:1024 lds
    s_add_u32 s69, s69, 16384
    s_add_u32 m0, s70, 2048
    s_nop 0
    buffer_load_dwordx4 v14, s[44:47], s69 offen lds
    buffer_load_dwordx4 v15, s[44:47], s69 offen offset:1024 lds
    s_lshl_b32 s72, s32, 15
    s_add_u32 m0, s71, 0
    s_add_u32 s72, s72, s60
    buffer_load_dwordx4 v16, s[48:51], s72 offen lds
    s_add_u32 s32, s32, 1
    s_and_b32 s32, s32, 15
    s_cmp_ge_u32 s26, 14
    s_cbranch_scc1 L_nlb_57
    s_barrier
L_nlb_57:
    s_lshl_b32 s72, s32, 15
    s_add_u32 m0, s71, 4096
    s_add_u32 s72, s72, s60
    buffer_load_dwordx4 v16, s[48:51], s72 offen lds
    s_add_u32 s32, s32, 1
    s_and_b32 s32, s32, 15
    s_lshl_b32 s72, s32, 15
    s_add_u32 m0, s71, 8192
    s_add_u32 s72, s72, s60
    buffer_load_dwordx4 v16, s[48:51], s72 offen lds
    s_add_u32 s32, s32, 1
    s_and_b32 s32, s32, 15
    s_lshl_b32 s72, s32, 15
    s_add_u32 m0, s71, 12288
    s_add_u32 s72, s72, s60
    buffer_load_dwordx4 v16, s[48:51], s72 offen lds
    s_add_u32 s32, s32, 1
    s_and_b32 s32, s32, 15
    s_lshl_b32 s69, s67, 7
    s_add_u32 s69, s69, s68
    s_add_u32 s67, s67, 1
    s_and_b32 s67, s67, 7
    s_add_u32 m0, s70, 16384
    s_nop 0
    buffer_load_dwordx4 v14, s[44:47], s69 offen lds
    buffer_load_dwordx4 v15, s[44:47], s69 offen offset:1024 lds
    s_mov_b32 s40, s22
    s_and_b32 s41, s23, 0xffff
    s_mov_b32 s42, 33554432
    s_mov_b32 s43, 0x20000
    s_add_u32 s36, s22, 7340032
    s_addc_u32 s37, s23, 0
    s_load_dwordx2 s[34:35], s[36:37], 0
    s_mov_b32 s52, s16
    s_and_b32 s53, s17, 0xffff
    s_mov_b32 s54, 1835008
    s_mov_b32 s55, 0x20000
    s_mov_b32 s56, s20
    s_and_b32 s57, s21, 0xffff
    s_mov_b32 s58, 524288
    s_mov_b32 s59, 0x20000
    s_and_b32 s27, s29, 1
    s_lshl_b32 s65, s30, 1
    s_add_u32 s65, s65, s27
    v_lshrrev_b32 v5, 2, v7
    v_and_b32 v6, 3, v1
    v_lshlrev_b32 v6, 3, v6
    v_lshl_add_u32 v4, v8, 3, v5
    v_lshl_add_u32 v19, v4, 7, v6
    v_and_b32 v3, 1, v8
    v_lshrrev_b32 v5, 1, v5
    v_lshl_or_b32 v3, v3, 1, v5
    v_xor_b32 v3, s29, v3
    v_lshl_add_u32 v19, v3, 5, v19
    v_xor_b32 v20, 32, v19
    v_lshrrev_b32 v3, 1, v7
    v_xor_b32 v3, v3, v8
    v_lshlrev_b32 v17, 7, v7
    v_lshl_add_u32 v17, v3, 4, v17
    s_lshl_b32 s27, s65, 12
    s_add_u32 s27, s27, 114688
    v_add_u32 v17, s27, v17
    v_xor_b32 v18, 64, v17
    s_and_b32 s27, s25, 3
    s_lshl_b32 s77, s27, 2
    s_add_u32 s77, s77, s29
    s_and_b32 s27, s77, 7
    v_lshrrev_b32 v3, 2, v7
    v_lshl_add_u32 v4, v8, 3, v3
    v_and_b32 v5, 1, v8
    v_lshl_add_u32 v5, v5, 2, v3
    v_xor_b32 v5, s27, v5
    v_lshlrev_b32 v21, 8, v4
    v_lshl_add_u32 v21, v5, 5, v21
    v_and_b32 v5, 3, v1
    v_lshl_add_u32 v21, v5, 3, v21
    v_add_u32 v21, 49152, v21
    s_lshr_b32 s27, s77, 3
    s_lshl_b32 s27, s27, 13
    v_add_u32 v21, s27, v21
    v_lshrrev_b32 v3, 3, v1
    v_lshlrev_b32 v9, 10, v3
    v_bfe_u32 v3, v1, 4, 1
    v_lshlrev_b32 v3, 2, v3
    v_and_b32 v4, 7, v1
    v_xor_b32 v3, v3, v4
    v_lshl_add_u32 v9, v3, 4, v9
    v_bfe_u32 v3, v1, 2, 2
    v_lshlrev_b32 v10, 7, v3
    v_lshrrev_b32 v4, 5, v1
    v_lshl_add_u32 v10, v4, 9, v10
    v_bfe_u32 v3, v1, 3, 1
    v_lshl_add_u32 v10, v3, 6, v10
    v_bfe_u32 v3, v1, 4, 1
    v_lshl_add_u32 v10, v3, 5, v10
    v_and_b32 v3, 3, v1
    v_lshl_add_u32 v10, v3, 3, v10
    s_lshl_b32 s63, s29, 13
    s_add_u32 s63, s63, 131072
    v_add_u32 v10, s63, v10
    s_and_b32 s28, s29, 2
    s_lshl_b32 s28, s28, 5
    v_xor_b32 v10, s28, v10
    v_xor_b32 v11, 64, v10
    v_and_b32 v3, 31, v1
    v_lshlrev_b32 v12, 10, v3
    v_lshrrev_b32 v4, 5, v1
    v_lshl_add_u32 v12, v4, 4, v12
    s_lshl_b32 s64, s25, 17
    s_lshl_b32 s27, s65, 15
    s_add_u32 s64, s64, s27
    s_add_u32 s64, s64, s62
    s_add_u32 s64, s64, s28
    v_mov_b32 v24, 0x3f803f80
    v_mov_b32 v25, 0x3f803f80
    v_mov_b32 v26, 0x3f803f80
    v_mov_b32 v27, 0x3f803f80
    v_and_b32 v132, 0x1ff, v2
    v_and_b32 v133, 0x7f, v2
    v_lshlrev_b32 v134, 4, v7
    s_getreg_b32 s74, hwreg(HW_REG_XCC_ID)
    s_and_b32 s74, s74, 0xf
    s_lshl_b32 s73, s25, 8
    s_lshl_b32 s27, s30, 7
    s_add_u32 s73, s73, s27
    s_add_u32 s73, s73, 7372800
    s_lshl_b32 s75, s25, 11
    s_lshl_b32 s27, s29, 9
    s_add_u32 s75, s75, s27
    s_add_u32 s75, s75, 7405568
    s_mov_b32 s76, 7344128
    s_waitcnt lgkmcnt(0)
    s_mul_i32 s34, s34, 1664525
    s_add_u32 s34, s34, 1013904223
    s_mul_i32 s35, s35, 22695477
    s_add_u32 s35, s35, 1
    v_mov_b32 v70, s34
    v_mov_b32 v71, s35
    s_setprio 3
    s_waitcnt vmcnt(5)
    s_barrier
    ds_read_b128 v[72:75], v17 offset:0
    ds_read_b128 v[76:79], v17 offset:2048
    ds_read_b64_tr_b16 v[88:89], v19 offset:32768
    ds_read_b64_tr_b16 v[90:91], v19 offset:33280
    ds_read_b64_tr_b16 v[92:93], v20 offset:32768
    ds_read_b64_tr_b16 v[94:95], v20 offset:33280
    ds_read_b64_tr_b16 v[64:65], v21 offset:0
    ds_read_b64_tr_b16 v[66:67], v21 offset:1024
    s_add_u32 s69, s69, 16384
    s_add_u32 m0, s70, 18432
    s_nop 0
    buffer_load_dwordx4 v14, s[44:47], s69 offen lds
    buffer_load_dwordx4 v15, s[44:47], s69 offen offset:1024 lds
    s_waitcnt lgkmcnt(0)
    s_waitcnt vmcnt(6)
    s_barrier
    v_mfma_f32_16x16x32_bf16 v[108:111], v[88:91], v[72:75], 0
    v_mfma_f32_16x16x32_bf16 v[112:115], v[92:95], v[72:75], 0
    v_mfma_f32_16x16x32_bf16 v[116:119], v[88:91], v[76:79], 0
    v_mfma_f32_16x16x32_bf16 v[120:123], v[92:95], v[76:79], 0
    v_mfma_f32_16x16x32_bf16 v[124:127], v[88:91], v[24:27], 0
    v_mfma_f32_16x16x32_bf16 v[60:63], v[64:67], v[24:27], 0
    ds_read_b128 v[80:83], v18 offset:0
    ds_read_b128 v[84:87], v18 offset:2048
    ds_read_b64_tr_b16 v[96:97], v19 offset:36864
    ds_read_b64_tr_b16 v[98:99], v19 offset:37376
    ds_read_b64_tr_b16 v[100:101], v20 offset:36864
    ds_read_b64_tr_b16 v[102:103], v20 offset:37376
    ds_read_b64_tr_b16 v[104:105], v21 offset:16384
    ds_read_b64_tr_b16 v[106:107], v21 offset:17408
    s_lshl_b32 s69, s67, 7
    s_add_u32 s69, s69, s68
    s_add_u32 s67, s67, 1
    s_and_b32 s67, s67, 7
    s_add_u32 m0, s70, 32768
    s_nop 0
    buffer_load_dwordx4 v14, s[44:47], s69 offen lds
    buffer_load_dwordx4 v15, s[44:47], s69 offen offset:1024 lds
    s_waitcnt lgkmcnt(0)
    s_waitcnt vmcnt(2)
    s_barrier
    v_mfma_f32_16x16x32_bf16 v[108:111], v[96:99], v[80:83], v[108:111]
    v_mfma_f32_16x16x32_bf16 v[112:115], v[100:103], v[80:83], v[112:115]
    v_mfma_f32_16x16x32_bf16 v[116:119], v[96:99], v[84:87], v[116:119]
    v_mfma_f32_16x16x32_bf16 v[120:123], v[100:103], v[84:87], v[120:123]
    v_mfma_f32_16x16x32_bf16 v[124:127], v[96:99], v[24:27], v[124:127]
    v_mfma_f32_16x16x32_bf16 v[60:63], v[104:107], v[24:27], v[60:63]
    ds_read_b128 v[72:75], v17 offset:16384
    ds_read_b128 v[76:79], v17 offset:18432
    ds_read_b64_tr_b16 v[88:89], v19 offset:40960
    ds_read_b64_tr_b16 v[90:91], v19 offset:41472
    ds_read_b64_tr_b16 v[92:93], v20 offset:40960
    ds_read_b64_tr_b16 v[94:95], v20 offset:41472
    ds_read_b64_tr_b16 v[64:65], v21 offset:32768
    ds_read_b64_tr_b16 v[66:67], v21 offset:33792
    s_lshl_b32 s72, s32, 15
    s_add_u32 m0, s71, 0
    s_add_u32 s72, s72, s60
    buffer_load_dwordx4 v16, s[48:51], s72 offen lds
    s_add_u32 s32, s32, 1
    s_and_b32 s32, s32, 15
    s_add_u32 s69, s69, 16384
    s_add_u32 m0, s70, 34816
    s_nop 0
    buffer_load_dwordx4 v14, s[44:47], s69 offen lds
    buffer_load_dwordx4 v15, s[44:47], s69 offen offset:1024 lds
    s_waitcnt lgkmcnt(0)
    s_lshl_b32 s27, s31, 4
    v_mov_b32 v3, s27
    v_mov_b32 v68, s74
    v_mov_b32 v69, 0
    s_mov_b64 exec, 1
    buffer_store_dwordx4 v[68:71], v3, s[40:43], s73 offen sc1
    s_mov_b64 exec, -1
    s_waitcnt vmcnt(5)
    s_barrier
    v_mfma_f32_16x16x32_bf16 v[108:111], v[88:91], v[72:75], v[108:111]
    v_mfma_f32_16x16x32_bf16 v[112:115], v[92:95], v[72:75], v[112:115]
    v_mfma_f32_16x16x32_bf16 v[116:119], v[88:91], v[76:79], v[116:119]
    v_mfma_f32_16x16x32_bf16 v[120:123], v[92:95], v[76:79], v[120:123]
    v_mfma_f32_16x16x32_bf16 v[124:127], v[88:91], v[24:27], v[124:127]
    v_mfma_f32_16x16x32_bf16 v[60:63], v[64:67], v[24:27], v[60:63]
    ds_read_b128 v[80:83], v18 offset:16384
    ds_read_b128 v[84:87], v18 offset:18432
    ds_read_b64_tr_b16 v[96:97], v19 offset:45056
    ds_read_b64_tr_b16 v[98:99], v19 offset:45568
    ds_read_b64_tr_b16 v[100:101], v20 offset:45056
    ds_read_b64_tr_b16 v[102:103], v20 offset:45568
    ds_read_b64_tr_b16 v[104:105], v21 offset:49152
    ds_read_b64_tr_b16 v[106:107], v21 offset:50176
    s_lshl_b32 s72, s32, 15
    s_add_u32 m0, s71, 4096
    s_add_u32 s72, s72, s60
    buffer_load_dwordx4 v16, s[48:51], s72 offen lds
    s_add_u32 s32, s32, 1
    s_and_b32 s32, s32, 15
    s_lshl_b32 s69, s67, 7
    s_add_u32 s69, s69, s68
    s_add_u32 s67, s67, 1
    s_and_b32 s67, s67, 7
    s_add_u32 m0, s70, 0
    s_nop 0
    buffer_load_dwordx4 v14, s[44:47], s69 offen lds
    buffer_load_dwordx4 v15, s[44:47], s69 offen offset:1024 lds
    s_waitcnt lgkmcnt(0)
    s_waitcnt vmcnt(3)
    s_barrier
    v_mfma_f32_16x16x32_bf16 v[108:111], v[96:99], v[80:83], v[108:111]
    v_mfma_f32_16x16x32_bf16 v[112:115], v[100:103], v[80:83], v[112:115]
    v_mfma_f32_16x16x32_bf16 v[116:119], v[96:99], v[84:87], v[116:119]
    v_mfma_f32_16x16x32_bf16 v[120:123], v[100:103], v[84:87], v[120:123]
    v_mfma_f32_16x16x32_bf16 v[124:127], v[96:99], v[24:27], v[124:127]
    v_mfma_f32_16x16x32_bf16 v[60:63], v[104:107], v[24:27], v[60:63]
    ds_read_b128 v[72:75], v17 offset:32768
    ds_read_b128 v[76:79], v17 offset:34816
    ds_read_b64_tr_b16 v[88:89], v19 offset:32768
    ds_read_b64_tr_b16 v[90:91], v19 offset:33280
    ds_read_b64_tr_b16 v[92:93], v20 offset:32768
    ds_read_b64_tr_b16 v[94:95], v20 offset:33280
    s_lshl_b32 s72, s32, 15
    s_add_u32 m0, s71, 8192
    s_add_u32 s72, s72, s60
    buffer_load_dwordx4 v16, s[48:51], s72 offen lds
    s_add_u32 s32, s32, 1
    s_and_b32 s32, s32, 15
    s_add_u32 s69, s69, 16384
    s_add_u32 m0, s70, 2048
    s_nop 0
    buffer_load_dwordx4 v14, s[44:47], s69 offen lds
    buffer_load_dwordx4 v15, s[44:47], s69 offen offset:1024 lds
    s_waitcnt lgkmcnt(0)
    v_cmp_eq_u32 vcc, 1, v7
    s_lshr_b32 s28, s25, 2
    s_lshl_b32 s33, s26, 13
    s_lshl_b32 s27, s77, 9
    s_add_u32 s33, s33, s27
    s_lshl_b32 s27, s28, 7
    s_add_u32 s33, s33, s27
    s_add_u32 s33, s33, 7471104
    s_lshl_b32 s78, s26, 13
    s_lshl_b32 s27, s29, 11
    s_add_u32 s78, s78, s27
    s_add_u32 s78, s78, 7471104
    v_cndmask_b32 v68, v60, v62, vcc
    v_cndmask_b32 v69, v61, v63, vcc
    v_lshl_add_u32 v3, v8, 5, v134
    s_mov_b32 exec_lo, 0x00030003
    s_mov_b32 exec_hi, 0x00030003
    buffer_store_dwordx4 v[68:71], v3, s[40:43], s33 offen sc1
    s_mov_b64 exec, -1
    s_waitcnt vmcnt(5)
    s_barrier
    v_mfma_f32_16x16x32_bf16 v[108:111], v[88:91], v[72:75], v[108:111]
    v_mfma_f32_16x16x32_bf16 v[112:115], v[92:95], v[72:75], v[112:115]
    v_mfma_f32_16x16x32_bf16 v[116:119], v[88:91], v[76:79], v[116:119]
    v_mfma_f32_16x16x32_bf16 v[120:123], v[92:95], v[76:79], v[120:123]
    v_mfma_f32_16x16x32_bf16 v[124:127], v[88:91], v[24:27], v[124:127]
    ds_read_b128 v[80:83], v18 offset:32768
    ds_read_b128 v[84:87], v18 offset:34816
    ds_read_b64_tr_b16 v[96:97], v19 offset:36864
    ds_read_b64_tr_b16 v[98:99], v19 offset:37376
    ds_read_b64_tr_b16 v[100:101], v20 offset:36864
    ds_read_b64_tr_b16 v[102:103], v20 offset:37376
    s_lshl_b32 s72, s32, 15
    s_add_u32 m0, s71, 12288
    s_add_u32 s72, s72, s60
    buffer_load_dwordx4 v16, s[48:51], s72 offen lds
    s_add_u32 s32, s32, 1
    s_and_b32 s32, s32, 15
    s_lshl_b32 s69, s67, 7
    s_add_u32 s69, s69, s68
    s_add_u32 s67, s67, 1
    s_and_b32 s67, s67, 7
    s_add_u32 m0, s70, 16384
    s_nop 0
    buffer_load_dwordx4 v14, s[44:47], s69 offen lds
    buffer_load_dwordx4 v15, s[44:47], s69 offen offset:1024 lds
    s_waitcnt lgkmcnt(0)
    s_waitcnt vmcnt(3)
    s_barrier
    v_mfma_f32_16x16x32_bf16 v[108:111], v[96:99], v[80:83], v[108:111]
    v_mfma_f32_16x16x32_bf16 v[112:115], v[100:103], v[80:83], v[112:115]
    v_mfma_f32_16x16x32_bf16 v[116:119], v[96:99], v[84:87], v[116:119]
    v_mfma_f32_16x16x32_bf16 v[120:123], v[100:103], v[84:87], v[120:123]
    v_mfma_f32_16x16x32_bf16 v[124:127], v[96:99], v[24:27], v[124:127]
    ds_read_b128 v[72:75], v17 offset:0
    ds_read_b128 v[76:79], v17 offset:2048
    ds_read_b64_tr_b16 v[88:89], v19 offset:40960
    ds_read_b64_tr_b16 v[90:91], v19 offset:41472
    ds_read_b64_tr_b16 v[92:93], v20 offset:40960
    ds_read_b64_tr_b16 v[94:95], v20 offset:41472
    s_lshl_b32 s72, s32, 15
    s_add_u32 m0, s71, 0
    s_add_u32 s72, s72, s60
    buffer_load_dwordx4 v16, s[48:51], s72 offen lds
    s_add_u32 s32, s32, 1
    s_and_b32 s32, s32, 15
    s_add_u32 s69, s69, 16384
    s_add_u32 m0, s70, 18432
    s_nop 0
    buffer_load_dwordx4 v14, s[44:47], s69 offen lds
    buffer_load_dwordx4 v15, s[44:47], s69 offen offset:1024 lds
    s_waitcnt lgkmcnt(0)
    s_waitcnt vmcnt(5)
    s_barrier
    v_mfma_f32_16x16x32_bf16 v[108:111], v[88:91], v[72:75], v[108:111]
    v_mfma_f32_16x16x32_bf16 v[112:115], v[92:95], v[72:75], v[112:115]
    v_mfma_f32_16x16x32_bf16 v[116:119], v[88:91], v[76:79], v[116:119]
    v_mfma_f32_16x16x32_bf16 v[120:123], v[92:95], v[76:79], v[120:123]
    v_mfma_f32_16x16x32_bf16 v[124:127], v[88:91], v[24:27], v[124:127]
    ds_read_b128 v[80:83], v18 offset:0
    ds_read_b128 v[84:87], v18 offset:2048
    ds_read_b64_tr_b16 v[96:97], v19 offset:45056
    ds_read_b64_tr_b16 v[98:99], v19 offset:45568
    ds_read_b64_tr_b16 v[100:101], v20 offset:45056
    ds_read_b64_tr_b16 v[102:103], v20 offset:45568
    s_lshl_b32 s72, s32, 15
    s_add_u32 m0, s71, 4096
    s_add_u32 s72, s72, s60
    buffer_load_dwordx4 v16, s[48:51], s72 offen lds
    s_add_u32 s32, s32, 1
    s_and_b32 s32, s32, 15
    s_lshl_b32 s69, s67, 7
    s_add_u32 s69, s69, s68
    s_add_u32 s67, s67, 1
    s_and_b32 s67, s67, 7
    s_add_u32 m0, s70, 32768
    s_nop 0
    buffer_load_dwordx4 v14, s[44:47], s69 offen lds
    buffer_load_dwordx4 v15, s[44:47], s69 offen offset:1024 lds
    s_waitcnt lgkmcnt(0)
    s_waitcnt vmcnt(3)
    s_barrier
    v_mfma_f32_16x16x32_bf16 v[108:111], v[96:99], v[80:83], v[108:111]
    v_mfma_f32_16x16x32_bf16 v[112:115], v[100:103], v[80:83], v[112:115]
    v_mfma_f32_16x16x32_bf16 v[116:119], v[96:99], v[84:87], v[116:119]
    v_mfma_f32_16x16x32_bf16 v[120:123], v[100:103], v[84:87], v[120:123]
    v_mfma_f32_16x16x32_bf16 v[124:127], v[96:99], v[24:27], v[124:127]
    ds_read_b128 v[72:75], v17 offset:16384
    ds_read_b128 v[76:79], v17 offset:18432
    ds_read_b64_tr_b16 v[88:89], v19 offset:32768
    ds_read_b64_tr_b16 v[90:91], v19 offset:33280
    ds_read_b64_tr_b16 v[92:93], v20 offset:32768
    ds_read_b64_tr_b16 v[94:95], v20 offset:33280
    s_lshl_b32 s72, s32, 15
    s_add_u32 m0, s71, 8192
    s_add_u32 s72, s72, s60
    buffer_load_dwordx4 v16, s[48:51], s72 offen lds
    s_add_u32 s32, s32, 1
    s_and_b32 s32, s32, 15
    s_add_u32 s69, s69, 16384
    s_add_u32 m0, s70, 34816
    s_nop 0
    buffer_load_dwordx4 v14, s[44:47], s69 offen lds
    buffer_load_dwordx4 v15, s[44:47], s69 offen offset:1024 lds
    s_waitcnt lgkmcnt(0)
    s_waitcnt vmcnt(5)
    s_barrier
    v_mfma_f32_16x16x32_bf16 v[108:111], v[88:91], v[72:75], v[108:111]
    v_mfma_f32_16x16x32_bf16 v[112:115], v[92:95], v[72:75], v[112:115]
    v_mfma_f32_16x16x32_bf16 v[116:119], v[88:91], v[76:79], v[116:119]
    v_mfma_f32_16x16x32_bf16 v[120:123], v[92:95], v[76:79], v[120:123]
    v_mfma_f32_16x16x32_bf16 v[124:127], v[88:91], v[24:27], v[124:127]
    ds_read_b128 v[80:83], v18 offset:16384
    ds_read_b128 v[84:87], v18 offset:18432
    ds_read_b64_tr_b16 v[96:97], v19 offset:36864
    ds_read_b64_tr_b16 v[98:99], v19 offset:37376
    ds_read_b64_tr_b16 v[100:101], v20 offset:36864
    ds_read_b64_tr_b16 v[102:103], v20 offset:37376
    s_lshl_b32 s72, s32, 15
    s_add_u32 m0, s71, 12288
    s_add_u32 s72, s72, s60
    buffer_load_dwordx4 v16, s[48:51], s72 offen lds
    s_add_u32 s32, s32, 1
    s_and_b32 s32, s32, 15
    s_lshl_b32 s69, s67, 7
    s_add_u32 s69, s69, s68
    s_add_u32 s67, s67, 1
    s_and_b32 s67, s67, 7
    s_add_u32 m0, s70, 0
    s_nop 0
    buffer_load_dwordx4 v14, s[44:47], s69 offen lds
    buffer_load_dwordx4 v15, s[44:47], s69 offen offset:1024 lds
    s_waitcnt lgkmcnt(0)
    s_waitcnt vmcnt(3)
    s_barrier
    v_mfma_f32_16x16x32_bf16 v[108:111], v[96:99], v[80:83], v[108:111]
    v_mfma_f32_16x16x32_bf16 v[112:115], v[100:103], v[80:83], v[112:115]
    v_mfma_f32_16x16x32_bf16 v[116:119], v[96:99], v[84:87], v[116:119]
    v_mfma_f32_16x16x32_bf16 v[120:123], v[100:103], v[84:87], v[120:123]
    v_mfma_f32_16x16x32_bf16 v[124:127], v[96:99], v[24:27], v[124:127]
    ds_read_b128 v[72:75], v17 offset:32768
    ds_read_b128 v[76:79], v17 offset:34816
    ds_read_b64_tr_b16 v[88:89], v19 offset:40960
    ds_read_b64_tr_b16 v[90:91], v19 offset:41472
    ds_read_b64_tr_b16 v[92:93], v20 offset:40960
    ds_read_b64_tr_b16 v[94:95], v20 offset:41472
    s_lshl_b32 s72, s32, 15
    s_add_u32 m0, s71, 0
    s_add_u32 s72, s72, s60
    buffer_load_dwordx4 v16, s[48:51], s72 offen lds
    s_add_u32 s32, s32, 1
    s_and_b32 s32, s32, 15
    s_add_u32 s69, s69, 16384
    s_add_u32 m0, s70, 2048
    s_nop 0
    buffer_load_dwordx4 v14, s[44:47], s69 offen lds
    buffer_load_dwordx4 v15, s[44:47], s69 offen offset:1024 lds
    s_waitcnt lgkmcnt(0)
    s_waitcnt vmcnt(5)
    s_barrier
    v_mfma_f32_16x16x32_bf16 v[108:111], v[88:91], v[72:75], v[108:111]
    v_mfma_f32_16x16x32_bf16 v[112:115], v[92:95], v[72:75], v[112:115]
    v_mfma_f32_16x16x32_bf16 v[116:119], v[88:91], v[76:79], v[116:119]
    v_mfma_f32_16x16x32_bf16 v[120:123], v[92:95], v[76:79], v[120:123]
    v_mfma_f32_16x16x32_bf16 v[124:127], v[88:91], v[24:27], v[124:127]
    ds_read_b128 v[80:83], v18 offset:32768
    ds_read_b128 v[84:87], v18 offset:34816
    ds_read_b64_tr_b16 v[96:97], v19 offset:45056
    ds_read_b64_tr_b16 v[98:99], v19 offset:45568
    ds_read_b64_tr_b16 v[100:101], v20 offset:45056
    ds_read_b64_tr_b16 v[102:103], v20 offset:45568
    s_lshl_b32 s72, s32, 15
    s_add_u32 m0, s71, 4096
    s_add_u32 s72, s72, s60
    buffer_load_dwordx4 v16, s[48:51], s72 offen lds
    s_add_u32 s32, s32, 1
    s_and_b32 s32, s32, 15
    s_lshl_b32 s69, s67, 7
    s_add_u32 s69, s69, s68
    s_add_u32 s67, s67, 1
    s_and_b32 s67, s67, 7
    s_add_u32 m0, s70, 16384
    s_nop 0
    buffer_load_dwordx4 v14, s[44:47], s69 offen lds
    buffer_load_dwordx4 v15, s[44:47], s69 offen offset:1024 lds
    s_waitcnt lgkmcnt(0)
    s_waitcnt vmcnt(3)
    s_barrier
    v_mfma_f32_16x16x32_bf16 v[108:111], v[96:99], v[80:83], v[108:111]
    v_mfma_f32_16x16x32_bf16 v[112:115], v[100:103], v[80:83], v[112:115]
    v_mfma_f32_16x16x32_bf16 v[116:119], v[96:99], v[84:87], v[116:119]
    v_mfma_f32_16x16x32_bf16 v[120:123], v[100:103], v[84:87], v[120:123]
    v_mfma_f32_16x16x32_bf16 v[124:127], v[96:99], v[24:27], v[124:127]
    ds_read_b128 v[72:75], v17 offset:0
    ds_read_b128 v[76:79], v17 offset:2048
    ds_read_b64_tr_b16 v[88:89], v19 offset:32768
    ds_read_b64_tr_b16 v[90:91], v19 offset:33280
    ds_read_b64_tr_b16 v[92:93], v20 offset:32768
    ds_read_b64_tr_b16 v[94:95], v20 offset:33280
    s_lshl_b32 s72, s32, 15
    s_add_u32 m0, s71, 8192
    s_add_u32 s72, s72, s60
    buffer_load_dwordx4 v16, s[48:51], s72 offen lds
    s_add_u32 s32, s32, 1
    s_and_b32 s32, s32, 15
    s_add_u32 s69, s69, 16384
    s_add_u32 m0, s70, 18432
    s_nop 0
    buffer_load_dwordx4 v14, s[44:47], s69 offen lds
    buffer_load_dwordx4 v15, s[44:47], s69 offen offset:1024 lds
    s_waitcnt lgkmcnt(0)
    buffer_load_dwordx4 v[28:31], v2, s[40:43], s78 offen offset:0 sc1
    buffer_load_dwordx4 v[32:35], v2, s[40:43], s78 offen offset:1024 sc1
    buffer_load_dwordx4 v[36:39], v132, s[40:43], s75 offen sc1
    buffer_load_dwordx4 v[44:47], v133, s[40:43], s73 offen sc1
    s_waitcnt vmcnt(9)
    s_barrier
    v_mfma_f32_16x16x32_bf16 v[108:111], v[88:91], v[72:75], v[108:111]
    v_mfma_f32_16x16x32_bf16 v[112:115], v[92:95], v[72:75], v[112:115]
    v_mfma_f32_16x16x32_bf16 v[116:119], v[88:91], v[76:79], v[116:119]
    v_mfma_f32_16x16x32_bf16 v[120:123], v[92:95], v[76:79], v[120:123]
    v_mfma_f32_16x16x32_bf16 v[124:127], v[88:91], v[24:27], v[124:127]
    ds_read_b128 v[80:83], v18 offset:0
    ds_read_b128 v[84:87], v18 offset:2048
    ds_read_b64_tr_b16 v[96:97], v19 offset:36864
    ds_read_b64_tr_b16 v[98:99], v19 offset:37376
    ds_read_b64_tr_b16 v[100:101], v20 offset:36864
    ds_read_b64_tr_b16 v[102:103], v20 offset:37376
    s_lshl_b32 s72, s32, 15
    s_add_u32 m0, s71, 12288
    s_add_u32 s72, s72, s60
    buffer_load_dwordx4 v16, s[48:51], s72 offen lds
    s_add_u32 s32, s32, 1
    s_and_b32 s32, s32, 15
    s_waitcnt lgkmcnt(0)
    s_waitcnt vmcnt(5)
    s_barrier
    v_mfma_f32_16x16x32_bf16 v[108:111], v[96:99], v[80:83], v[108:111]
    v_mfma_f32_16x16x32_bf16 v[112:115], v[100:103], v[80:83], v[112:115]
    v_mfma_f32_16x16x32_bf16 v[116:119], v[96:99], v[84:87], v[116:119]
    v_mfma_f32_16x16x32_bf16 v[120:123], v[100:103], v[84:87], v[120:123]
    v_mfma_f32_16x16x32_bf16 v[124:127], v[96:99], v[24:27], v[124:127]
    ds_read_b128 v[72:75], v17 offset:16384
    ds_read_b128 v[76:79], v17 offset:18432
    ds_read_b64_tr_b16 v[88:89], v19 offset:40960
    ds_read_b64_tr_b16 v[90:91], v19 offset:41472
    ds_read_b64_tr_b16 v[92:93], v20 offset:40960
    ds_read_b64_tr_b16 v[94:95], v20 offset:41472
    s_waitcnt lgkmcnt(0)
    s_waitcnt vmcnt(0)
    v_cmpx_eq_u64 vcc, s[34:35], v[30:31]
    v_cmpx_eq_u64 vcc, s[34:35], v[34:35]
    v_cmpx_eq_u64 vcc, s[34:35], v[38:39]
    v_cmpx_eq_u64 vcc, s[34:35], v[46:47]
    s_nop 4
    s_cmp_eq_u64 exec, -1
    s_mov_b64 exec, -1
    s_cselect_b32 s66, 1, 0
    s_cbranch_scc1 L_gok_58
    s_mov_b32 s61, 0
L_gsp_59:
    buffer_load_dwordx4 v[28:31], v2, s[40:43], s78 offen offset:0 sc1
    buffer_load_dwordx4 v[32:35], v2, s[40:43], s78 offen offset:1024 sc1
    buffer_load_dwordx4 v[36:39], v132, s[40:43], s75 offen sc1
    buffer_load_dwordx4 v[44:47], v133, s[40:43], s73 offen sc1
    s_waitcnt vmcnt(0)
    v_cmpx_eq_u64 vcc, s[34:35], v[30:31]
    v_cmpx_eq_u64 vcc, s[34:35], v[34:35]
    v_cmpx_eq_u64 vcc, s[34:35], v[38:39]
    v_cmpx_eq_u64 vcc, s[34:35], v[46:47]
    s_nop 4
    s_cmp_eq_u64 exec, -1
    s_mov_b64 exec, -1
    s_cbranch_scc1 L_gspo_60
    s_sleep 8
    s_add_u32 s61, s61, 1
    s_cmp_lt_u32 s61, 32768
    s_cbranch_scc1 L_gsp_59
L_gspo_60:
L_gok_58:
    buffer_load_dwordx4 v[40:43], v134, s[40:43], s76 offen sc1
    s_waitcnt vmcnt(1)
    s_barrier
    v_mfma_f32_16x16x32_bf16 v[108:111], v[88:91], v[72:75], v[108:111]
    v_mfma_f32_16x16x32_bf16 v[112:115], v[92:95], v[72:75], v[112:115]
    v_mfma_f32_16x16x32_bf16 v[116:119], v[88:91], v[76:79], v[116:119]
    v_mfma_f32_16x16x32_bf16 v[120:123], v[92:95], v[76:79], v[120:123]
    v_mfma_f32_16x16x32_bf16 v[124:127], v[88:91], v[24:27], v[124:127]
    ds_read_b128 v[80:83], v18 offset:16384
    ds_read_b128 v[84:87], v18 offset:18432
    ds_read_b64_tr_b16 v[96:97], v19 offset:45056
    ds_read_b64_tr_b16 v[98:99], v19 offset:45568
    ds_read_b64_tr_b16 v[100:101], v20 offset:45056
    ds_read_b64_tr_b16 v[102:103], v20 offset:45568
    s_waitcnt lgkmcnt(0)
    v_mfma_f32_16x16x32_bf16 v[108:111], v[96:99], v[80:83], v[108:111]
    v_mfma_f32_16x16x32_bf16 v[112:115], v[100:103], v[80:83], v[112:115]
    v_mfma_f32_16x16x32_bf16 v[116:119], v[96:99], v[84:87], v[116:119]
    v_mfma_f32_16x16x32_bf16 v[120:123], v[100:103], v[84:87], v[120:123]
    v_mfma_f32_16x16x32_bf16 v[124:127], v[96:99], v[24:27], v[124:127]
    v_add_f32 v28, v28, v28 row_ror:8 row_mask:0xf bank_mask:0xf
    v_add_f32 v29, v29, v29 row_ror:8 row_mask:0xf bank_mask:0xf
    v_add_f32 v32, v32, v32 row_ror:8 row_mask:0xf bank_mask:0xf
    v_add_f32 v33, v33, v33 row_ror:8 row_mask:0xf bank_mask:0xf
    v_mov_b32 v136, v28
    v_mov_b32 v137, v29
    v_mov_b32 v138, v32
    v_mov_b32 v139, v33
    v_rsq_f32 v4, v37
    v_mov_b32 v39, v37
    v_permlane16_swap_b32 v28, v136
    v_permlane16_swap_b32 v29, v137
    v_permlane16_swap_b32 v32, v138
    v_permlane16_swap_b32 v33, v139
    v_mul_f32 v37, 0xc0135761, v4
    v_mul_f32 v5, v4, v4
    v_mul_f32 v5, v5, v4
    v_mul_f32 v38, 0xbdd2d3e8, v5
    v_add_f32 v28, v28, v136
    v_add_f32 v29, v29, v137
    v_add_f32 v32, v32, v138
    v_add_f32 v33, v33, v139
    v_cmp_ne_u32 vcc, s74, v44
    s_lshl_b32 s27, s29, 8
    s_add_u32 s27, s27, 149504
    v_and_b32 v3, 7, v1
    v_lshl_add_u32 v3, v3, 3, s27
    v_lshrrev_b32 v5, 5, v1
    v_lshl_add_u32 v3, v5, 6, v3
    ds_write_b64 v3, v[28:29]
    ds_write_b64 v3, v[32:33] offset:128
    s_lshl_b32 s27, s29, 9
    s_add_u32 s27, s27, 147456
    v_add_u32 v3, s27, v132
    ds_write_b128 v3, v[36:39]
    s_cmp_eq_u64 vcc, 0
    s_cselect_b32 s27, 1, 0
    v_mov_b32 v3, 151040
    v_mov_b32 v4, s27
    ds_write_b32 v3, v4
    s_lshl_b32 s27, s29, 6
    s_add_u32 s27, s27, 150528
    v_lshl_add_u32 v3, v8, 4, s27
    ds_write_b128 v3, v[124:127]
    s_waitcnt lgkmcnt(0)
    s_barrier
    s_waitcnt vmcnt(0)
    v_cmpx_eq_u64 vcc, s[34:35], v[40:41]
    v_cmpx_eq_u64 vcc, s[34:35], v[42:43]
    s_nop 4
    s_cmp_eq_u64 exec, -1
    s_mov_b64 exec, -1
    s_cbranch_scc1 L_kok_61
    s_mov_b32 s61, 0
L_ksp_62:
    buffer_load_dwordx4 v[40:43], v134, s[40:43], s76 offen sc1
    s_waitcnt vmcnt(0)
    v_cmpx_eq_u64 vcc, s[34:35], v[40:41]
    v_cmpx_eq_u64 vcc, s[34:35], v[42:43]
    s_nop 4
    s_cmp_eq_u64 exec, -1
    s_mov_b64 exec, -1
    s_cbranch_scc1 L_kspo_63
    s_sleep 4
    s_add_u32 s61, s61, 1
    s_cmp_lt_u32 s61, 32768
    s_cbranch_scc1 L_ksp_62
L_kspo_63:
L_kok_61:
    s_mul_i32 s27, s29, 8192
    s_add_u32 s27, s27, 0
    s_add_u32 s28, s27, 6291456
    s_mov_b32 m0, s27
    s_nop 0
    buffer_load_dwordx4 v2, s[40:43], s28 offen offset:0 sc1 lds
    buffer_load_dwordx4 v2, s[40:43], s28 offen offset:1024 sc1 lds
    buffer_load_dwordx4 v2, s[40:43], s28 offen offset:2048 sc1 lds
    buffer_load_dwordx4 v2, s[40:43], s28 offen offset:3072 sc1 lds
    s_add_u32 s27, s27, 4096
    s_add_u32 s28, s28, 4096
    s_mov_b32 m0, s27
    s_nop 0
    buffer_load_dwordx4 v2, s[40:43], s28 offen offset:0 sc1 lds
    buffer_load_dwordx4 v2, s[40:43], s28 offen offset:1024 sc1 lds
    buffer_load_dwordx4 v2, s[40:43], s28 offen offset:2048 sc1 lds
    buffer_load_dwordx4 v2, s[40:43], s28 offen offset:3072 sc1 lds
    s_add_u32 s27, s27, 4096
    s_add_u32 s28, s28, 4096
    s_lshl_b32 s27, s65, 9
    s_add_u32 s27, s27, 147456
    v_add_u32 v4, s27, v134
    ds_read_b64 v[28:29], v4 offset:0
    ds_read_b64 v[32:33], v4 offset:256
    v_xor_b32 v3, 64, v3
    ds_read_b128 v[128:131], v3
    s_lshl_b32 s27, s29, 11
    s_add_u32 s27, s27, 151552
    v_add_u32 v6, s27, v134
    v_and_b32 v3, 1, v8
    v_lshl_add_u32 v6, v3, 9, v6
    v_lshrrev_b32 v3, 1, v8
    v_lshl_add_u32 v6, v3, 3, v6
    s_waitcnt lgkmcnt(0)
    s_and_b32 s27, s29, 1
    s_lshl_b32 s27, s27, 10
    v_xor_b32 v6, s27, v6
    v_xor_b32 v5, 1024, v6
    v_mul_f32 v30, 0xbe206c99, v29
    v_pk_fma_f32 v[108:109], v[124:125], v[28:29], v[108:109] op_sel_hi:[1,0,1]
    v_pk_fma_f32 v[110:111], v[126:127], v[28:29], v[110:111] op_sel_hi:[1,0,1]
    v_pk_fma_f32 v[112:113], v[128:129], v[28:29], v[112:113] op_sel_hi:[1,0,1]
    v_pk_fma_f32 v[114:115], v[130:131], v[28:29], v[114:115] op_sel_hi:[1,0,1]
    v_pk_mul_f32 v[108:109], v[108:109], v[30:31] op_sel_hi:[1,0]
    v_pk_mul_f32 v[110:111], v[110:111], v[30:31] op_sel_hi:[1,0]
    v_pk_mul_f32 v[112:113], v[112:113], v[30:31] op_sel_hi:[1,0]
    v_pk_mul_f32 v[114:115], v[114:115], v[30:31] op_sel_hi:[1,0]
    v_cvt_pk_bf16_f32 v108, v108, v109
    v_cvt_pk_bf16_f32 v109, v110, v111
    ds_write_b64 v6, v[108:109] offset:0
    v_cvt_pk_bf16_f32 v112, v112, v113
    v_cvt_pk_bf16_f32 v113, v114, v115
    ds_write_b64 v5, v[112:113] offset:0
    v_mul_f32 v34, 0xbe206c99, v33
    v_pk_fma_f32 v[116:117], v[124:125], v[32:33], v[116:117] op_sel_hi:[1,0,1]
    v_pk_fma_f32 v[118:119], v[126:127], v[32:33], v[118:119] op_sel_hi:[1,0,1]
    v_pk_fma_f32 v[120:121], v[128:129], v[32:33], v[120:121] op_sel_hi:[1,0,1]
    v_pk_fma_f32 v[122:123], v[130:131], v[32:33], v[122:123] op_sel_hi:[1,0,1]
    v_pk_mul_f32 v[116:117], v[116:117], v[34:35] op_sel_hi:[1,0]
    v_pk_mul_f32 v[118:119], v[118:119], v[34:35] op_sel_hi:[1,0]
    v_pk_mul_f32 v[120:121], v[120:121], v[34:35] op_sel_hi:[1,0]
    v_pk_mul_f32 v[122:123], v[122:123], v[34:35] op_sel_hi:[1,0]
    v_cvt_pk_bf16_f32 v116, v116, v117
    v_cvt_pk_bf16_f32 v117, v118, v119
    ds_write_b64 v6, v[116:117] offset:256
    v_cvt_pk_bf16_f32 v120, v120, v121
    v_cvt_pk_bf16_f32 v121, v122, v123
    ds_write_b64 v5, v[120:121] offset:256
    s_waitcnt vmcnt(0) lgkmcnt(0)
    s_mov_b32 s48, s18
    s_and_b32 s49, s19, 0xffff
    s_mov_b32 s50, 2097152
    s_mov_b32 s51, 0x20000
    v_lshlrev_b32 v13, 3, v1
    v_mov_b32 v116, 0
    v_mov_b32 v117, 0
    v_mov_b32 v118, 0
    v_mov_b32 v119, 0
    s_mul_i32 s67, s25, 458752
    s_mul_i32 s27, s65, 114688
    s_add_u32 s67, s67, s27
    s_mul_i32 s27, s29, 28672
    s_add_u32 s67, s67, s27
    s_add_u32 s67, s67, 8388608
    s_xor_b32 s28, s65, 1
    s_mul_i32 s68, s25, 458752
    s_mul_i32 s27, s28, 114688
    s_add_u32 s68, s68, s27
    s_mul_i32 s27, s29, 28672
    s_add_u32 s68, s68, s27
    s_add_u32 s68, s68, 8388608
    s_mul_i32 s69, s29, 458752
    s_add_u32 s69, s69, s62
    s_add_u32 s70, s69, 7168
    s_lshl_b32 s33, s25, 10
    s_lshl_b32 s27, s30, 9
    s_add_u32 s33, s33, s27
    s_add_u32 s33, s33, 7356416
    v_mfma_f32_32x32x16_bf16 v[16:31], v[116:119], v[116:119], 0
    v_mfma_f32_32x32x16_bf16 v[32:47], v[116:119], v[116:119], 0
    v_mfma_f32_32x32x16_bf16 v[48:63], v[116:119], v[116:119], 0
    v_mfma_f32_32x32x16_bf16 v[64:79], v[116:119], v[116:119], 0
    v_add_u32 v160, s63, v2
    s_lshl_b32 s27, s29, 12
    v_add_u32 v161, s27, v2
    s_lshl_b32 s27, s29, 14
    s_add_u32 s27, s27, 114688
    s_cmp_eq_u32 s29, 3
    s_cselect_b32 s27, 0, s27
    v_add_u32 v162, s27, v2
    s_barrier
    s_mul_i32 s27, s29, 24576
    s_add_u32 s27, s27, 32768
    s_add_u32 s28, s27, 6291456
    s_mov_b32 m0, s27
    s_nop 0
    buffer_load_dwordx4 v2, s[40:43], s28 offen offset:0 sc1 lds
    buffer_load_dwordx4 v2, s[40:43], s28 offen offset:1024 sc1 lds
    buffer_load_dwordx4 v2, s[40:43], s28 offen offset:2048 sc1 lds
    buffer_load_dwordx4 v2, s[40:43], s28 offen offset:3072 sc1 lds
    s_add_u32 s27, s27, 4096
    s_add_u32 s28, s28, 4096
    s_mov_b32 m0, s27
    s_nop 0
    buffer_load_dwordx4 v2, s[40:43], s28 offen offset:0 sc1 lds
    buffer_load_dwordx4 v2, s[40:43], s28 offen offset:1024 sc1 lds
    buffer_load_dwordx4 v2, s[40:43], s28 offen offset:2048 sc1 lds
    buffer_load_dwordx4 v2, s[40:43], s28 offen offset:3072 sc1 lds
    s_add_u32 s27, s27, 4096
    s_add_u32 s28, s28, 4096
    s_mov_b32 m0, s27
    s_nop 0
    buffer_load_dwordx4 v2, s[40:43], s28 offen offset:0 sc1 lds
    buffer_load_dwordx4 v2, s[40:43], s28 offen offset:1024 sc1 lds
    buffer_load_dwordx4 v2, s[40:43], s28 offen offset:2048 sc1 lds
    buffer_load_dwordx4 v2, s[40:43], s28 offen offset:3072 sc1 lds
    s_add_u32 s27, s27, 4096
    s_add_u32 s28, s28, 4096
    s_mov_b32 m0, s27
    s_nop 0
    buffer_load_dwordx4 v2, s[40:43], s28 offen offset:0 sc1 lds
    buffer_load_dwordx4 v2, s[40:43], s28 offen offset:1024 sc1 lds
    buffer_load_dwordx4 v2, s[40:43], s28 offen offset:2048 sc1 lds
    buffer_load_dwordx4 v2, s[40:43], s28 offen offset:3072 sc1 lds
    s_add_u32 s27, s27, 4096
    s_add_u32 s28, s28, 4096
    s_mov_b32 m0, s27
    s_nop 0
    buffer_load_dwordx4 v2, s[40:43], s28 offen offset:0 sc1 lds
    buffer_load_dwordx4 v2, s[40:43], s28 offen offset:1024 sc1 lds
    buffer_load_dwordx4 v2, s[40:43], s28 offen offset:2048 sc1 lds
    buffer_load_dwordx4 v2, s[40:43], s28 offen offset:3072 sc1 lds
    s_add_u32 s27, s27, 4096
    s_add_u32 s28, s28, 4096
    s_mov_b32 m0, s27
    s_nop 0
    buffer_load_dwordx4 v2, s[40:43], s28 offen offset:0 sc1 lds
    buffer_load_dwordx4 v2, s[40:43], s28 offen offset:1024 sc1 lds
    buffer_load_dwordx4 v2, s[40:43], s28 offen offset:2048 sc1 lds
    buffer_load_dwordx4 v2, s[40:43], s28 offen offset:3072 sc1 lds
    s_add_u32 s27, s27, 4096
    s_add_u32 s28, s28, 4096
    s_waitcnt vmcnt(0)
    s_barrier
    s_mov_b32 s61, 0
L_hsp_64:
    buffer_load_dwordx2 v[112:113], v13, s[40:43], s33 offen sc1
    s_waitcnt vmcnt(0)
    v_cmpx_eq_u64 vcc, s[34:35], v[112:113]
    s_nop 4
    s_cmp_eq_u64 exec, -1
    s_mov_b64 exec, -1
    s_cbranch_scc1 L_hspo_65
    s_sleep 8
    s_add_u32 s61, s61, 1
    s_cmp_lt_u32 s61, 32768
    s_cbranch_scc1 L_hsp_64
L_hspo_65:
    s_setprio 0
    s_add_u32 m0, s63, 0
    buffer_load_dwordx4 v[80:83], v2, s[40:43], s67 offen offset:0 sc1
    buffer_load_dwordx4 v9, s[52:55], s69 offen lds
    buffer_load_dwordx4 v9, s[52:55], s70 offen offset:1024 lds
    buffer_load_dwordx4 v[84:87], v2, s[40:43], s68 offen offset:0 sc1
    s_add_u32 s69, s69, 16384
    s_add_u32 s70, s70, 16384
    s_add_u32 m0, s63, 2048
    buffer_load_dwordx4 v[88:91], v2, s[40:43], s67 offen offset:1024 sc1
    buffer_load_dwordx4 v9, s[52:55], s69 offen lds
    buffer_load_dwordx4 v9, s[52:55], s70 offen offset:1024 lds
    buffer_load_dwordx4 v[92:95], v2, s[40:43], s68 offen offset:1024 sc1
    s_add_u32 s69, s69, 16384
    s_add_u32 s70, s70, 16384
    s_add_u32 m0, s63, 4096
    buffer_load_dwordx4 v[96:99], v2, s[40:43], s67 offen offset:2048 sc1
    buffer_load_dwordx4 v9, s[52:55], s69 offen lds
    buffer_load_dwordx4 v9, s[52:55], s70 offen offset:1024 lds
    buffer_load_dwordx4 v[100:103], v2, s[40:43], s68 offen offset:2048 sc1
    s_add_u32 s69, s69, 16384
    s_add_u32 s70, s70, 16384
    s_add_u32 m0, s63, 6144
    buffer_load_dwordx4 v[104:107], v2, s[40:43], s67 offen offset:3072 sc1
    buffer_load_dwordx4 v9, s[52:55], s69 offen lds
    buffer_load_dwordx4 v9, s[52:55], s70 offen offset:1024 lds
    buffer_load_dwordx4 v[108:111], v2, s[40:43], s68 offen offset:3072 sc1
    s_add_u32 s69, s69, 16384
    s_add_u32 s70, s70, 16384
    s_add_u32 s67, s67, 4096
    s_add_u32 s68, s68, 4096
    s_mov_b32 s71, 0
L_dloop_66:
    s_waitcnt vmcnt(12)
    ds_read_b64_tr_b16 v[112:113], v10 offset:0
    ds_read_b64_tr_b16 v[114:115], v10 offset:1024
    ds_read_b64_tr_b16 v[116:117], v11 offset:0
    ds_read_b64_tr_b16 v[118:119], v11 offset:1024
    s_waitcnt lgkmcnt(0)
    v_mfma_f32_32x32x16_bf16 v[16:31], v[112:115], v[80:83], v[16:31]
    v_mfma_f32_32x32x16_bf16 v[32:47], v[116:119], v[80:83], v[32:47]
    v_mfma_f32_32x32x16_bf16 v[48:63], v[112:115], v[84:87], v[48:63]
    v_mfma_f32_32x32x16_bf16 v[64:79], v[116:119], v[84:87], v[64:79]
    s_add_u32 m0, s63, 0
    buffer_load_dwordx4 v[80:83], v2, s[40:43], s67 offen offset:0 sc1
    buffer_load_dwordx4 v9, s[52:55], s69 offen lds
    buffer_load_dwordx4 v9, s[52:55], s70 offen offset:1024 lds
    buffer_load_dwordx4 v[84:87], v2, s[40:43], s68 offen offset:0 sc1
    s_add_u32 s69, s69, 16384
    s_add_u32 s70, s70, 16384
    s_waitcnt vmcnt(12)
    ds_read_b64_tr_b16 v[112:113], v10 offset:2048
    ds_read_b64_tr_b16 v[114:115], v10 offset:3072
    ds_read_b64_tr_b16 v[116:117], v11 offset:2048
    ds_read_b64_tr_b16 v[118:119], v11 offset:3072
    s_waitcnt lgkmcnt(0)
    v_mfma_f32_32x32x16_bf16 v[16:31], v[112:115], v[88:91], v[16:31]
    v_mfma_f32_32x32x16_bf16 v[32:47], v[116:119], v[88:91], v[32:47]
    v_mfma_f32_32x32x16_bf16 v[48:63], v[112:115], v[92:95], v[48:63]
    v_mfma_f32_32x32x16_bf16 v[64:79], v[116:119], v[92:95], v[64:79]
    s_add_u32 m0, s63, 2048
    buffer_load_dwordx4 v[88:91], v2, s[40:43], s67 offen offset:1024 sc1
    buffer_load_dwordx4 v9, s[52:55], s69 offen lds
    buffer_load_dwordx4 v9, s[52:55], s70 offen offset:1024 lds
    buffer_load_dwordx4 v[92:95], v2, s[40:43], s68 offen offset:1024 sc1
    s_add_u32 s69, s69, 16384
    s_add_u32 s70, s70, 16384
    s_waitcnt vmcnt(12)
    ds_read_b64_tr_b16 v[112:113], v10 offset:4096
    ds_read_b64_tr_b16 v[114:115], v10 offset:5120
    ds_read_b64_tr_b16 v[116:117], v11 offset:4096
    ds_read_b64_tr_b16 v[118:119], v11 offset:5120
    s_waitcnt lgkmcnt(0)
    v_mfma_f32_32x32x16_bf16 v[16:31], v[112:115], v[96:99], v[16:31]
    v_mfma_f32_32x32x16_bf16 v[32:47], v[116:119], v[96:99], v[32:47]
    v_mfma_f32_32x32x16_bf16 v[48:63], v[112:115], v[100:103], v[48:63]
    v_mfma_f32_32x32x16_bf16 v[64:79], v[116:119], v[100:103], v[64:79]
    s_add_u32 m0, s63, 4096
    buffer_load_dwordx4 v[96:99], v2, s[40:43], s67 offen offset:2048 sc1
    buffer_load_dwordx4 v9, s[52:55], s69 offen lds
    buffer_load_dwordx4 v9, s[52:55], s70 offen offset:1024 lds
    buffer_load_dwordx4 v[100:103], v2, s[40:43], s68 offen offset:2048 sc1
    s_add_u32 s69, s69, 16384
    s_add_u32 s70, s70, 16384
    s_waitcnt vmcnt(12)
    ds_read_b64_tr_b16 v[112:113], v10 offset:6144
    ds_read_b64_tr_b16 v[114:115], v10 offset:7168
    ds_read_b64_tr_b16 v[116:117], v11 offset:6144
    ds_read_b64_tr_b16 v[118:119], v11 offset:7168
    s_waitcnt lgkmcnt(0)
    v_mfma_f32_32x32x16_bf16 v[16:31], v[112:115], v[104:107], v[16:31]
    v_mfma_f32_32x32x16_bf16 v[32:47], v[116:119], v[104:107], v[32:47]
    v_mfma_f32_32x32x16_bf16 v[48:63], v[112:115], v[108:111], v[48:63]
    v_mfma_f32_32x32x16_bf16 v[64:79], v[116:119], v[108:111], v[64:79]
    s_add_u32 m0, s63, 6144
    buffer_load_dwordx4 v[104:107], v2, s[40:43], s67 offen offset:3072 sc1
    buffer_load_dwordx4 v9, s[52:55], s69 offen lds
    buffer_load_dwordx4 v9, s[52:55], s70 offen offset:1024 lds
    buffer_load_dwordx4 v[108:111], v2, s[40:43], s68 offen offset:3072 sc1
    s_add_u32 s69, s69, 16384
    s_add_u32 s70, s70, 16384
    s_add_u32 s67, s67, 4096
    s_add_u32 s68, s68, 4096
    s_add_u32 s71, s71, 1
    s_cmp_lt_u32 s71, 6
    s_cbranch_scc1 L_dloop_66
    s_waitcnt vmcnt(12)
    ds_read_b64_tr_b16 v[112:113], v10 offset:0
    ds_read_b64_tr_b16 v[114:115], v10 offset:1024
    ds_read_b64_tr_b16 v[116:117], v11 offset:0
    ds_read_b64_tr_b16 v[118:119], v11 offset:1024
    s_waitcnt lgkmcnt(0)
    v_mfma_f32_32x32x16_bf16 v[16:31], v[112:115], v[80:83], v[16:31]
    v_mfma_f32_32x32x16_bf16 v[32:47], v[116:119], v[80:83], v[32:47]
    v_mfma_f32_32x32x16_bf16 v[48:63], v[112:115], v[84:87], v[48:63]
    v_mfma_f32_32x32x16_bf16 v[64:79], v[116:119], v[84:87], v[64:79]
    s_waitcnt vmcnt(8)
    ds_read_b64_tr_b16 v[112:113], v10 offset:2048
    ds_read_b64_tr_b16 v[114:115], v10 offset:3072
    ds_read_b64_tr_b16 v[116:117], v11 offset:2048
    ds_read_b64_tr_b16 v[118:119], v11 offset:3072
    s_waitcnt lgkmcnt(0)
    v_mfma_f32_32x32x16_bf16 v[16:31], v[112:115], v[88:91], v[16:31]
    v_mfma_f32_32x32x16_bf16 v[32:47], v[116:119], v[88:91], v[32:47]
    v_mfma_f32_32x32x16_bf16 v[48:63], v[112:115], v[92:95], v[48:63]
    v_mfma_f32_32x32x16_bf16 v[64:79], v[116:119], v[92:95], v[64:79]
    s_waitcnt vmcnt(4)
    ds_read_b64_tr_b16 v[112:113], v10 offset:4096
    ds_read_b64_tr_b16 v[114:115], v10 offset:5120
    ds_read_b64_tr_b16 v[116:117], v11 offset:4096
    ds_read_b64_tr_b16 v[118:119], v11 offset:5120
    s_waitcnt lgkmcnt(0)
    v_mfma_f32_32x32x16_bf16 v[16:31], v[112:115], v[96:99], v[16:31]
    v_mfma_f32_32x32x16_bf16 v[32:47], v[116:119], v[96:99], v[32:47]
    v_mfma_f32_32x32x16_bf16 v[48:63], v[112:115], v[100:103], v[48:63]
    v_mfma_f32_32x32x16_bf16 v[64:79], v[116:119], v[100:103], v[64:79]
    s_waitcnt vmcnt(0)
    ds_read_b64_tr_b16 v[112:113], v10 offset:6144
    ds_read_b64_tr_b16 v[114:115], v10 offset:7168
    ds_read_b64_tr_b16 v[116:117], v11 offset:6144
    ds_read_b64_tr_b16 v[118:119], v11 offset:7168
    s_waitcnt lgkmcnt(0)
    v_mfma_f32_32x32x16_bf16 v[16:31], v[112:115], v[104:107], v[16:31]
    v_mfma_f32_32x32x16_bf16 v[32:47], v[116:119], v[104:107], v[32:47]
    v_mfma_f32_32x32x16_bf16 v[48:63], v[112:115], v[108:111], v[48:63]
    v_mfma_f32_32x32x16_bf16 v[64:79], v[116:119], v[108:111], v[64:79]
    s_setprio 3
    buffer_load_dwordx4 v[152:155], v12, s[44:47], s64 offen offset:0
    buffer_load_dwordx4 v[156:159], v12, s[44:47], s64 offen offset:32
    s_lshl_b32 s33, s2, 6
    s_add_u32 s33, s33, 7389184
    v_and_b32 v6, 63, v13
    s_lshl_b32 s69, s29, 17
    s_add_u32 s69, s69, s62
    s_lshl_b32 s70, s29, 14
    s_add_u32 s70, s70, 16384
    s_nop 5
    ds_write_b128 v160, v[48:51] offset:0
    ds_write_b128 v160, v[52:55] offset:1024
    ds_write_b128 v160, v[56:59] offset:2048
    ds_write_b128 v160, v[60:63] offset:3072
    ds_write_b128 v160, v[32:35] offset:4096
    ds_write_b128 v160, v[36:39] offset:5120
    ds_write_b128 v160, v[40:43] offset:6144
    ds_write_b128 v160, v[44:47] offset:7168
    ds_write_b128 v161, v[64:67] offset:0
    ds_write_b128 v161, v[68:71] offset:1024
    ds_write_b128 v161, v[72:75] offset:2048
    ds_write_b128 v161, v[76:79] offset:3072
    s_mov_b32 s61, 0
L_psp_67:
    buffer_load_dwordx2 v[112:113], v6, s[40:43], s33 offen sc1
    s_waitcnt vmcnt(0)
    v_cmpx_eq_u64 vcc, s[34:35], v[112:113]
    s_nop 4
    s_cmp_eq_u64 exec, -1
    s_mov_b64 exec, -1
    s_cbranch_scc1 L_pspo_68
    s_sleep 8
    s_add_u32 s61, s61, 1
    s_cmp_lt_u32 s61, 32768
    s_cbranch_scc1 L_psp_67
L_pspo_68:
    s_add_u32 m0, s70, 0
    s_nop 0
    buffer_load_dwordx4 v9, s[56:59], s69 offen lds
    s_add_u32 s69, s69, 8192
    s_add_u32 m0, s70, 1024
    s_nop 0
    buffer_load_dwordx4 v9, s[56:59], s69 offen lds
    s_add_u32 s69, s69, 8192
    s_add_u32 m0, s70, 2048
    s_nop 0
    buffer_load_dwordx4 v9, s[56:59], s69 offen lds
    s_add_u32 s69, s69, 8192
    s_add_u32 m0, s70, 3072
    s_nop 0
    buffer_load_dwordx4 v9, s[56:59], s69 offen lds
    s_add_u32 s69, s69, 8192
    s_add_u32 m0, s70, 4096
    s_nop 0
    buffer_load_dwordx4 v9, s[56:59], s69 offen lds
    s_add_u32 s69, s69, 8192
    s_add_u32 m0, s70, 5120
    s_nop 0
    buffer_load_dwordx4 v9, s[56:59], s69 offen lds
    s_add_u32 s69, s69, 8192
    s_add_u32 m0, s70, 6144
    s_nop 0
    buffer_load_dwordx4 v9, s[56:59], s69 offen lds
    s_add_u32 s69, s69, 8192
    s_add_u32 m0, s70, 7168
    s_nop 0
    buffer_load_dwordx4 v9, s[56:59], s69 offen lds
    s_add_u32 s69, s69, 8192
    s_add_u32 m0, s70, 8192
    s_nop 0
    buffer_load_dwordx4 v9, s[56:59], s69 offen lds
    s_add_u32 s69, s69, 8192
    s_add_u32 m0, s70, 9216
    s_nop 0
    buffer_load_dwordx4 v9, s[56:59], s69 offen lds
    s_add_u32 s69, s69, 8192
    s_add_u32 m0, s70, 10240
    s_nop 0
    buffer_load_dwordx4 v9, s[56:59], s69 offen lds
    s_add_u32 s69, s69, 8192
    s_add_u32 m0, s70, 11264
    s_nop 0
    buffer_load_dwordx4 v9, s[56:59], s69 offen lds
    s_add_u32 s69, s69, 8192
    s_add_u32 m0, s70, 12288
    s_nop 0
    buffer_load_dwordx4 v9, s[56:59], s69 offen lds
    s_add_u32 s69, s69, 8192
    s_add_u32 m0, s70, 13312
    s_nop 0
    buffer_load_dwordx4 v9, s[56:59], s69 offen lds
    s_add_u32 s69, s69, 8192
    s_add_u32 m0, s70, 14336
    s_nop 0
    buffer_load_dwordx4 v9, s[56:59], s69 offen lds
    s_add_u32 s69, s69, 8192
    s_add_u32 m0, s70, 15360
    s_nop 0
    buffer_load_dwordx4 v9, s[56:59], s69 offen lds
    s_add_u32 s69, s69, 8192
    v_xor_b32 v10, 8192, v160
    v_xor_b32 v11, 16384, v160
    v_xor_b32 v161, 12288, v161
    v_permlane32_swap_b32 v152, v154
    v_permlane32_swap_b32 v153, v155
    v_permlane32_swap_b32 v156, v158
    v_permlane32_swap_b32 v157, v159
    s_nop 0
    v_lshlrev_b32 v136, 16, v152
    v_and_b32 v137, 0xffff0000, v152
    v_lshlrev_b32 v138, 16, v153
    v_and_b32 v139, 0xffff0000, v153
    v_lshlrev_b32 v140, 16, v154
    v_and_b32 v141, 0xffff0000, v154
    v_lshlrev_b32 v142, 16, v155
    v_and_b32 v143, 0xffff0000, v155
    v_lshlrev_b32 v144, 16, v156
    v_and_b32 v145, 0xffff0000, v156
    v_lshlrev_b32 v146, 16, v157
    v_and_b32 v147, 0xffff0000, v157
    v_lshlrev_b32 v148, 16, v158
    v_and_b32 v149, 0xffff0000, v158
    v_lshlrev_b32 v150, 16, v159
    v_and_b32 v151, 0xffff0000, v159
    s_waitcnt vmcnt(0) lgkmcnt(0)
    s_barrier
    s_barrier
    ds_read_b128 v[48:51], v10 offset:0
    ds_read_b128 v[52:55], v10 offset:1024
    ds_read_b128 v[56:59], v10 offset:2048
    ds_read_b128 v[60:63], v10 offset:3072
    ds_read_b128 v[32:35], v11 offset:4096
    ds_read_b128 v[36:39], v11 offset:5120
    ds_read_b128 v[40:43], v11 offset:6144
    ds_read_b128 v[44:47], v11 offset:7168
    ds_read_b128 v[64:67], v161 offset:0
    ds_read_b128 v[68:71], v161 offset:1024
    ds_read_b128 v[72:75], v161 offset:2048
    ds_read_b128 v[76:79], v161 offset:3072
    s_waitcnt lgkmcnt(0)
    s_barrier
    s_setprio 0
    v_add_f32 v16, v16, v48
    v_add_f32 v17, v17, v49
    v_add_f32 v18, v18, v50
    v_add_f32 v19, v19, v51
    v_add_f32 v20, v20, v52
    v_add_f32 v21, v21, v53
    v_add_f32 v22, v22, v54
    v_add_f32 v23, v23, v55
    v_add_f32 v24, v24, v56
    v_add_f32 v25, v25, v57
    v_add_f32 v26, v26, v58
    v_add_f32 v27, v27, v59
    v_add_f32 v28, v28, v60
    v_add_f32 v29, v29, v61
    v_add_f32 v30, v30, v62
    v_add_f32 v31, v31, v63
    v_add_f32 v32, v32, v64
    v_add_f32 v33, v33, v65
    v_add_f32 v34, v34, v66
    v_add_f32 v35, v35, v67
    v_add_f32 v36, v36, v68
    v_add_f32 v37, v37, v69
    v_add_f32 v38, v38, v70
    v_add_f32 v39, v39, v71
    v_add_f32 v40, v40, v72
    v_add_f32 v41, v41, v73
    v_add_f32 v42, v42, v74
    v_add_f32 v43, v43, v75
    v_add_f32 v44, v44, v76
    v_add_f32 v45, v45, v77
    v_add_f32 v46, v46, v78
    v_add_f32 v47, v47, v79
    v_add_f32 v120, v16, v32
    v_add_f32 v121, v17, v33
    v_add_f32 v122, v18, v34
    v_add_f32 v123, v19, v35
    v_add_f32 v124, v20, v36
    v_add_f32 v125, v21, v37
    v_add_f32 v126, v22, v38
    v_add_f32 v127, v23, v39
    v_add_f32 v128, v24, v40
    v_add_f32 v129, v25, v41
    v_add_f32 v130, v26, v42
    v_add_f32 v131, v27, v43
    v_add_f32 v132, v28, v44
    v_add_f32 v133, v29, v45
    v_add_f32 v134, v30, v46
    v_add_f32 v135, v31, v47
    v_mul_f32 v80, 0xbfb8aa3b, v120
    v_mul_f32 v81, 0xbfb8aa3b, v121
    v_mul_f32 v82, 0xbfb8aa3b, v122
    v_mul_f32 v83, 0xbfb8aa3b, v123
    v_mul_f32 v84, 0xbfb8aa3b, v124
    v_mul_f32 v85, 0xbfb8aa3b, v125
    v_mul_f32 v86, 0xbfb8aa3b, v126
    v_mul_f32 v87, 0xbfb8aa3b, v127
    v_mul_f32 v88, 0xbfb8aa3b, v128
    v_mul_f32 v89, 0xbfb8aa3b, v129
    v_mul_f32 v90, 0xbfb8aa3b, v130
    v_mul_f32 v91, 0xbfb8aa3b, v131
    v_mul_f32 v92, 0xbfb8aa3b, v132
    v_mul_f32 v93, 0xbfb8aa3b, v133
    v_mul_f32 v94, 0xbfb8aa3b, v134
    v_mul_f32 v95, 0xbfb8aa3b, v135
    v_exp_f32 v80, v80
    v_exp_f32 v81, v81
    v_exp_f32 v82, v82
    v_exp_f32 v83, v83
    v_exp_f32 v84, v84
    v_exp_f32 v85, v85
    v_exp_f32 v86, v86
    v_exp_f32 v87, v87
    v_exp_f32 v88, v88
    v_exp_f32 v89, v89
    v_exp_f32 v90, v90
    v_exp_f32 v91, v91
    v_exp_f32 v92, v92
    v_exp_f32 v93, v93
    v_exp_f32 v94, v94
    v_exp_f32 v95, v95
    v_add_f32 v80, 1.0, v80
    v_add_f32 v81, 1.0, v81
    v_add_f32 v82, 1.0, v82
    v_add_f32 v83, 1.0, v83
    v_add_f32 v84, 1.0, v84
    v_add_f32 v85, 1.0, v85
    v_add_f32 v86, 1.0, v86
    v_add_f32 v87, 1.0, v87
    v_add_f32 v88, 1.0, v88
    v_add_f32 v89, 1.0, v89
    v_add_f32 v90, 1.0, v90
    v_add_f32 v91, 1.0, v91
    v_add_f32 v92, 1.0, v92
    v_add_f32 v93, 1.0, v93
    v_add_f32 v94, 1.0, v94
    v_add_f32 v95, 1.0, v95
    v_rcp_f32 v80, v80
    v_rcp_f32 v81, v81
    v_rcp_f32 v82, v82
    v_rcp_f32 v83, v83
    v_rcp_f32 v84, v84
    v_rcp_f32 v85, v85
    v_rcp_f32 v86, v86
    v_rcp_f32 v87, v87
    v_rcp_f32 v88, v88
    v_rcp_f32 v89, v89
    v_rcp_f32 v90, v90
    v_rcp_f32 v91, v91
    v_rcp_f32 v92, v92
    v_rcp_f32 v93, v93
    v_rcp_f32 v94, v94
    v_rcp_f32 v95, v95
    v_mul_f32 v120, v120, v80
    v_mul_f32 v121, v121, v81
    v_mul_f32 v122, v122, v82
    v_mul_f32 v123, v123, v83
    v_mul_f32 v124, v124, v84
    v_mul_f32 v125, v125, v85
    v_mul_f32 v126, v126, v86
    v_mul_f32 v127, v127, v87
    v_mul_f32 v128, v128, v88
    v_mul_f32 v129, v129, v89
    v_mul_f32 v130, v130, v90
    v_mul_f32 v131, v131, v91
    v_mul_f32 v132, v132, v92
    v_mul_f32 v133, v133, v93
    v_mul_f32 v134, v134, v94
    v_mul_f32 v135, v135, v95
    s_barrier
    ds_read_b128 v[16:19], v162 offset:0
    ds_read_b128 v[48:51], v162 offset:4096
    ds_read_b128 v[32:35], v162 offset:8192
    ds_read_b128 v[64:67], v162 offset:12288
    ds_read_b128 v[20:23], v162 offset:1024
    ds_read_b128 v[52:55], v162 offset:5120
    ds_read_b128 v[36:39], v162 offset:9216
    ds_read_b128 v[68:71], v162 offset:13312
    ds_read_b128 v[24:27], v162 offset:2048
    ds_read_b128 v[56:59], v162 offset:6144
    ds_read_b128 v[40:43], v162 offset:10240
    ds_read_b128 v[72:75], v162 offset:14336
    s_waitcnt lgkmcnt(8)
    ds_read_b128 v[28:31], v162 offset:3072
    ds_read_b128 v[60:63], v162 offset:7168
    ds_read_b128 v[44:47], v162 offset:11264
    ds_read_b128 v[76:79], v162 offset:15360
    s_waitcnt lgkmcnt(8)
    s_waitcnt lgkmcnt(8)
    v_add_f32 v16, v16, v48
    v_add_f32 v32, v32, v64
    v_add_f32 v17, v17, v49
    v_add_f32 v33, v33, v65
    v_add_f32 v18, v18, v50
    v_add_f32 v34, v34, v66
    v_add_f32 v19, v19, v51
    v_add_f32 v35, v35, v67
    v_add_f32 v16, v16, v32
    v_add_f32 v17, v17, v33
    v_add_f32 v18, v18, v34
    v_add_f32 v19, v19, v35
    v_fma_f32 v16, v16, v120, v136
    v_fma_f32 v17, v17, v121, v137
    v_fma_f32 v18, v18, v122, v138
    v_fma_f32 v19, v19, v123, v139
    v_cvt_pk_bf16_f32 v152, v16, v17
    v_cvt_pk_bf16_f32 v153, v18, v19
    s_waitcnt lgkmcnt(8)
    v_add_f32 v20, v20, v52
    v_add_f32 v36, v36, v68
    v_add_f32 v21, v21, v53
    v_add_f32 v37, v37, v69
    v_add_f32 v22, v22, v54
    v_add_f32 v38, v38, v70
    v_add_f32 v23, v23, v55
    v_add_f32 v39, v39, v71
    v_add_f32 v20, v20, v36
    v_add_f32 v21, v21, v37
    v_add_f32 v22, v22, v38
    v_add_f32 v23, v23, v39
    v_fma_f32 v20, v20, v124, v140
    v_fma_f32 v21, v21, v125, v141
    v_fma_f32 v22, v22, v126, v142
    v_fma_f32 v23, v23, v127, v143
    v_cvt_pk_bf16_f32 v154, v20, v21
    v_cvt_pk_bf16_f32 v155, v22, v23
    s_nop 1
    v_permlane32_swap_b32 v152, v154
    v_permlane32_swap_b32 v153, v155
    buffer_store_dwordx4 v[152:155], v12, s[48:51], s64 offen offset:0
    s_waitcnt lgkmcnt(4)
    v_add_f32 v24, v24, v56
    v_add_f32 v40, v40, v72
    v_add_f32 v25, v25, v57
    v_add_f32 v41, v41, v73
    v_add_f32 v26, v26, v58
    v_add_f32 v42, v42, v74
    v_add_f32 v27, v27, v59
    v_add_f32 v43, v43, v75
    v_add_f32 v24, v24, v40
    v_add_f32 v25, v25, v41
    v_add_f32 v26, v26, v42
    v_add_f32 v27, v27, v43
    v_fma_f32 v24, v24, v128, v144
    v_fma_f32 v25, v25, v129, v145
    v_fma_f32 v26, v26, v130, v146
    v_fma_f32 v27, v27, v131, v147
    v_cvt_pk_bf16_f32 v156, v24, v25
    v_cvt_pk_bf16_f32 v157, v26, v27
    s_waitcnt lgkmcnt(0)
    v_add_f32 v28, v28, v60
    v_add_f32 v44, v44, v76
    v_add_f32 v29, v29, v61
    v_add_f32 v45, v45, v77
    v_add_f32 v30, v30, v62
    v_add_f32 v46, v46, v78
    v_add_f32 v31, v31, v63
    v_add_f32 v47, v47, v79
    v_add_f32 v28, v28, v44
    v_add_f32 v29, v29, v45
    v_add_f32 v30, v30, v46
    v_add_f32 v31, v31, v47
    v_fma_f32 v28, v28, v132, v148
    v_fma_f32 v29, v29, v133, v149
    v_fma_f32 v30, v30, v134, v150
    v_fma_f32 v31, v31, v135, v151
    v_cvt_pk_bf16_f32 v158, v28, v29
    v_cvt_pk_bf16_f32 v159, v30, v31
    s_nop 1
    v_permlane32_swap_b32 v156, v158
    v_permlane32_swap_b32 v157, v159
    buffer_store_dwordx4 v[156:159], v12, s[48:51], s64 offen offset:32
    s_lshl_b32 s27, s2, 4
    s_add_u32 s27, s27, s29
    s_cmp_lg_u32 s27, 0
    s_cbranch_scc1 L_nn_69
    v_mov_b32 v112, s34
    v_mov_b32 v113, s35
    v_mov_b32 v3, 0
    s_mov_b32 s27, 7340032
    s_mov_b64 exec, 1
    buffer_store_dwordx2 v[112:113], v3, s[40:43], s27 offen sc1
    s_mov_b64 exec, -1
L_nn_69:
    s_endpgm
L_code_end:
.section .rodata,"a"
.p2align 6
.amdhsa_kernel recurrent_scan__grouped_kv_mqa__geglu_ffn__prompt_kernel
  .amdhsa_next_free_vgpr 168
  .amdhsa_next_free_sgpr 79
  .amdhsa_accum_offset 168
  .amdhsa_group_segment_fixed_size 0
  .amdhsa_kernarg_size 96
  .amdhsa_user_sgpr_count 2
  .amdhsa_user_sgpr_kernarg_segment_ptr 1
  .amdhsa_system_sgpr_workgroup_id_x 1
  .amdhsa_float_denorm_mode_32 3
  .amdhsa_float_denorm_mode_16_64 3
.end_amdhsa_kernel
```
